```python
import torch

def _softmax(x, axis=-1):
    return torch.softmax(x, dim=axis)
def _gelu(x):
    return torch.nn.functional.gelu(x, approximate="tanh")
def _silu(x):
    return torch.nn.functional.silu(x)
def _sigmoid(x):
    return torch.sigmoid(x)
def _layernorm(x, axis=-1, eps=1e-5):
    m = x.mean(dim=axis, keepdim=True)
    v = x.var(dim=axis, keepdim=True, unbiased=False)
    return (x - m) / torch.sqrt(v + eps)
def _scatter_add(tgt, idx, src, axis=0):
    return tgt.clone().index_add_(axis, idx, src)
def _segment_sum(src, seg, n):
    out = torch.zeros((n,) + src.shape[1:], dtype=src.dtype)
    return out.index_add_(0, seg, src)
def _pad(x, pw):
    flat = tuple(v for pair in reversed(pw) for v in pair)
    return torch.nn.functional.pad(x, flat)

kernel_name = 'concat_heads__sliding_block_cached__sliding_block_cached__decode'

def setup_inputs():

    _w = (lambda a: (lambda t: t.to(torch.bfloat16) if t.is_floating_point() else t)(torch.as_tensor(a)))
    def _A_setup():
        B, Sq, D = 4, 1, 640
        Hq, Hkv, Sk, Dh = 32, 32, 8192, 128
        assert Hq % Hkv == 0, (Hq, Hkv)
        return {
            "x": _w((lambda *s: torch.randn(*s, dtype=torch.bfloat16) * 0.8)(B, Sq, D)),
            "k_cache": _w((lambda *s: torch.randn(*s, dtype=torch.bfloat16) * 0.8)(B, Hkv, Sk, Dh)),
            "v_cache": _w((lambda *s: torch.randn(*s, dtype=torch.bfloat16) * 0.05)(B, Hkv, Sk, Dh)),
            "wq": _w((lambda *s: torch.randn(*s, dtype=torch.bfloat16) * 0.8)(D, Hq * Dh) * (D ** -0.5)),
            "wo": _w((lambda *s: torch.randn(*s, dtype=torch.bfloat16) * 0.05)(Hq * Dh, D) * ((Hq * Dh) ** -0.5)),
        }
    _A_in = _A_setup()

    def _B_setup():
        B, Sq, D = 4, 1, 640
        Hq, Hkv, Sk, Dh = 32, 32, 8192, 128
        assert Hq % Hkv == 0, (Hq, Hkv)
        return {
            "x": _w((lambda *s: torch.randn(*s, dtype=torch.bfloat16) * 0.8)(B, Sq, D)),
            "k_cache": _w((lambda *s: torch.randn(*s, dtype=torch.bfloat16) * 0.8)(B, Hkv, Sk, Dh)),
            "v_cache": _w((lambda *s: torch.randn(*s, dtype=torch.bfloat16) * 0.05)(B, Hkv, Sk, Dh)),
            "wq": _w((lambda *s: torch.randn(*s, dtype=torch.bfloat16) * 0.8)(D, Hq * Dh) * (D ** -0.5)),
            "wo": _w((lambda *s: torch.randn(*s, dtype=torch.bfloat16) * 0.05)(Hq * Dh, D) * ((Hq * Dh) ** -0.5)),
        }
    _B_in = _B_setup()

    return {
        "A_x": _A_in["x"],
        "A_k_cache": _A_in["k_cache"],
        "A_v_cache": _A_in["v_cache"],
        "A_wq": _A_in["wq"],
        "A_wo": _A_in["wo"],
        "B_x": _B_in["x"],
        "B_k_cache": _B_in["k_cache"],
        "B_v_cache": _B_in["v_cache"],
        "B_wq": _B_in["wq"],
        "B_wo": _B_in["wo"],
    }

def reference(A_x, A_k_cache, A_v_cache, A_wq, A_wo, B_x, B_k_cache, B_v_cache, B_wq, B_wo):
    def _A_ref(x, k_cache, v_cache, wq, wo):
        B, Sq, D = x.shape
        Hq, Dh = 32, 128
        Hkv, Sk = k_cache.shape[1], k_cache.shape[2]
        W = min(4096, max(256, Sk // 4))
        rep = Hq // Hkv
        q = (lambda x, *d: x.permute(*d))((x @ wq).reshape(B, Sq, Hq, Dh), 0, 2, 1, 3)
        k = (lambda x, n, axis: torch.repeat_interleave(x, n, dim=axis))(k_cache[:, :, Sk - W:, :], rep, axis=1)
        v = (lambda x, n, axis: torch.repeat_interleave(x, n, dim=axis))(v_cache[:, :, Sk - W:, :], rep, axis=1)
        scores = torch.einsum("bhqd,bhkd->bhqk", q, k) * (Dh ** -0.5)
        p = _softmax(scores, axis=-1)
        o = torch.einsum("bhqk,bhkd->bhqd", p, v)
        return (lambda x, *d: x.permute(*d))(o, 0, 2, 1, 3).reshape(B, Sq, Hq * Dh) @ wo

    def _B_ref(x, k_cache, v_cache, wq, wo):
        B, Sq, D = x.shape
        Hq, Dh = 32, 128
        Hkv, Sk = k_cache.shape[1], k_cache.shape[2]
        W = min(4096, max(256, Sk // 4))
        rep = Hq // Hkv
        q = (lambda x, *d: x.permute(*d))((x @ wq).reshape(B, Sq, Hq, Dh), 0, 2, 1, 3)
        k = (lambda x, n, axis: torch.repeat_interleave(x, n, dim=axis))(k_cache[:, :, Sk - W:, :], rep, axis=1)
        v = (lambda x, n, axis: torch.repeat_interleave(x, n, dim=axis))(v_cache[:, :, Sk - W:, :], rep, axis=1)
        scores = torch.einsum("bhqd,bhkd->bhqk", q, k) * (Dh ** -0.5)
        p = _softmax(scores, axis=-1)
        o = torch.einsum("bhqk,bhkd->bhqd", p, v)
        return (lambda x, *d: x.permute(*d))(o, 0, 2, 1, 3).reshape(B, Sq, Hq * Dh) @ wo

    a = _A_ref(A_x, A_k_cache, A_v_cache, A_wq, A_wo)
    b = _B_ref(B_x, B_k_cache, B_v_cache, B_wq, B_wo)
    return torch.concatenate([a, b], axis=-1)
```

```asm
; @launch grid=(256,1,1) block=(256,1,1) lds=16384
.amdgcn_target "amdgcn-amd-amdhsa--gfx950"
.text
.globl concat_heads__sliding_block_cached__sliding_block_cached__decode_kernel
.p2align 8
.type concat_heads__sliding_block_cached__sliding_block_cached__decode_kernel,@function
concat_heads__sliding_block_cached__sliding_block_cached__decode_kernel:
    s_cmp_ge_u32 s2, 256
    s_cbranch_scc1 L_end
    s_bfe_u32 s32, s2, 0x10005
    s_mul_i32 s3, s32, 40
    s_load_dwordx4 s[24:27], s[0:1], 80
    s_load_dwordx2 s[28:29], s[0:1], 96
    s_add_u32 s0, s0, s3
    s_addc_u32 s1, s1, 0
    s_load_dwordx8 s[56:63], s[0:1], 0
    s_load_dwordx2 s[64:65], s[0:1], 32
    v_lshrrev_b32 v5, 6, v0
    v_mov_b32 v140, v0
    v_and_b32 v0, 63, v0
    v_readfirstlane_b32 s30, v5
    v_lshrrev_b32 v137, 4, v0
    v_bfe_u32 v17, v0, 2, 2
    v_and_b32 v18, 3, v0
    v_lshlrev_b32 v20, 6, v137
    v_lshlrev_b32 v21, 8, v17
    v_lshlrev_b32 v22, 4, v18
    v_add3_u32 v1, v20, v21, v22
    s_lshr_b32 s31, s2, 6
    s_and_b32 s33, s2, 31
    s_lshl_b32 s3, s31, 5
    s_add_u32 s3, s3, s33
    s_lshr_b32 s39, s3, 11
    s_lshl_b32 s51, s3, 21
    s_add_u32 s51, s51, 0x180000
    s_lshl_b32 s34, s30, 12
    s_mov_b32 s6, 0x80000
    s_mov_b32 s7, 0x20000
    v_and_b32 v19, 15, v0
    v_lshlrev_b32 v23, 4, v19
    v_lshl_add_u32 v3, v137, 13, v23
    s_mul_i32 s36, s30, 1310720
    s_lshl_b32 s66, s33, 8
    s_sub_u32 s14, 5242880, s66
    s_mov_b32 s15, 0x20000
    v_lshl_add_u32 v24, v17, 2, v137
    s_mul_i32 s3, s30, 320
    v_lshl_add_u32 v5, v24, 1, s3
    s_mul_i32 s67, s31, 1280
    s_mov_b32 s22, 1280
    s_mov_b32 s23, 0x20000
    s_waitcnt lgkmcnt(0)
    s_add_u32 s4, s58, s51
    s_addc_u32 s5, s59, s39
    s_add_u32 s12, s62, s66
    s_addc_u32 s13, s63, 0
    s_add_u32 s20, s56, s67
    s_addc_u32 s21, s57, 0
    s_add_u32 s38, s36, 0
    buffer_load_dwordx4 a[0:3], v3, s[12:15], s38 offen
    s_add_u32 s38, s36, 32768
    buffer_load_dwordx4 a[4:7], v3, s[12:15], s38 offen
    s_add_u32 s38, s36, 65536
    buffer_load_dwordx4 a[8:11], v3, s[12:15], s38 offen
    s_add_u32 s38, s36, 98304
    buffer_load_dwordx4 a[12:15], v3, s[12:15], s38 offen
    buffer_load_dwordx4 a[16:19], v1, s[4:7], s34 offen offset:0 nt
    buffer_load_dwordx4 a[20:23], v1, s[4:7], s34 offen offset:1024 nt
    buffer_load_dwordx4 a[24:27], v1, s[4:7], s34 offen offset:2048 nt
    buffer_load_dwordx4 a[28:31], v1, s[4:7], s34 offen offset:3072 nt
    s_add_u32 s34, s34, 16384
    buffer_load_ushort v60, v5, s[20:23], 0 offen offset:0
    buffer_load_ushort v61, v5, s[20:23], 0 offen offset:32
    buffer_load_ushort v62, v5, s[20:23], 0 offen offset:64
    buffer_load_ushort v63, v5, s[20:23], 0 offen offset:96
    buffer_load_ushort v64, v5, s[20:23], 0 offen offset:128
    buffer_load_ushort v65, v5, s[20:23], 0 offen offset:160
    buffer_load_ushort v66, v5, s[20:23], 0 offen offset:192
    buffer_load_ushort v67, v5, s[20:23], 0 offen offset:224
    buffer_load_ushort v68, v5, s[20:23], 0 offen offset:256
    buffer_load_ushort v69, v5, s[20:23], 0 offen offset:288
    v_lshlrev_b32 v2, 4, v0
    v_mul_u32_u24 v20, 1280, v137
    v_add_u32 v4, v20, v23
    s_lshl_b32 s35, s30, 12
    s_mul_i32 s37, s30, 40960
    s_add_u32 s8, s60, s51
    s_addc_u32 s9, s61, s39
    s_mov_b32 s10, 0x80000
    s_mov_b32 s11, 0x20000
    s_mul_i32 s66, s33, 163840
    s_add_u32 s16, s64, s66
    s_addc_u32 s17, s65, 0
    s_mov_b32 s18, 163840
    s_mov_b32 s19, 0x20000
    buffer_load_dword v96, v2, s[8:11], s35 offen
    buffer_load_dword v97, v4, s[16:19], s37 offen
    s_lshl_b32 s49, s32, 2
    s_add_u32 s49, s49, s31
    s_mul_i32 s50, s33, 2560
    s_mul_i32 s66, s49, 81920
    s_add_u32 s52, s28, s66
    s_addc_u32 s53, s29, 0
    s_mov_b32 s54, 81920
    s_mov_b32 s55, 0x20000
    s_mov_b32 s68, s24
    s_mov_b32 s69, s25
    s_mov_b32 s70, 10240
    s_mov_b32 s71, 0x20000
    v_lshrrev_b32 v145, 3, v0
    v_mul_u32_u24 v145, 2560, v145
    v_and_b32 v92, 7, v0
    v_lshl_add_u32 v145, v92, 4, v145
    s_lshl_b32 s75, s33, 9
    s_lshl_b32 s3, s30, 7
    s_add_u32 s75, s75, s3
    s_add_u32 s76, s75, 20480
    s_add_u32 s77, s75, 40960
    s_add_u32 s78, s75, 61440
    s_cmp_ge_u32 s33, 5
    s_cbranch_scc1 L_noclear
    v_mov_b32 v92, -1
    v_mov_b32 v93, -1
    v_mov_b32 v94, -1
    v_mov_b32 v95, -1
    buffer_store_dwordx4 v[92:95], v145, s[52:55], s75 offen sc1
    buffer_store_dwordx4 v[92:95], v145, s[52:55], s76 offen sc1
    buffer_store_dwordx4 v[92:95], v145, s[52:55], s77 offen sc1
    buffer_store_dwordx4 v[92:95], v145, s[52:55], s78 offen sc1
L_noclear:
    s_mov_b32 s40, 0x000f000f
    s_mov_b32 s41, 0x000f000f
    s_mov_b32 s42, 0x00f000f0
    s_mov_b32 s43, 0x00f000f0
    s_mov_b32 s44, 0x0f000f00
    s_mov_b32 s45, 0x0f000f00
    s_mov_b32 s46, 0xf000f000
    s_mov_b32 s47, 0xf000f000
    s_mov_b32 s48, 0x3e0293ee
    v_and_b32 v20, 1, v0
    v_cmp_eq_u32 vcc, 1, v20
    v_mov_b32 v21, 0x0c0c0100
    v_mov_b32 v22, 0x01000c0c
    v_mov_b32 v25, 0x0c0c0302
    v_mov_b32 v26, 0x03020c0c
    v_mov_b32 v27, 0x0c0c0c0c
    v_cndmask_b32 v21, v21, v22, vcc
    v_cndmask_b32 v25, v25, v26, vcc
    v_cmp_gt_u32 vcc, 2, v18
    s_nop 1
    v_cndmask_b32 v6, v27, v21, vcc
    v_cndmask_b32 v7, v21, v27, vcc
    v_cndmask_b32 v8, v27, v25, vcc
    v_cndmask_b32 v9, v25, v27, vcc
    v_lshlrev_b32 v136, 5, v19
    v_lshl_add_u32 v136, v137, 3, v136
    s_mul_i32 s3, s30, 2560
    v_add_u32 v143, s3, v136
    v_add_u32 v142, s3, v2
    s_lshl_b32 s3, s30, 9
    v_add_u32 v136, s3, v136
    v_lshl_add_u32 v138, v137, 2, v18
    v_lshlrev_b32 v138, 5, v138
    v_lshlrev_b32 v139, 2, v24
    s_lshl_b32 s3, s30, 7
    v_add_u32 v139, s3, v139
    v_lshlrev_b32 v141, 4, v140
    v_and_b32 v20, 1, v140
    v_lshlrev_b32 v20, 10, v20
    v_lshrrev_b32 v21, 1, v140
    v_lshl_add_u32 v20, v21, 4, v20
    v_cmp_gt_u32 vcc, 128, v140
    v_min_u32 v146, 4, v0
    s_mul_i32 s3, s49, 5
    v_cndmask_b32 v144, v141, v20, vcc
    v_add_u32 v146, s3, v146
    v_lshlrev_b32 v146, 2, v146
    v_and_b32 v20, 7, v0
    v_lshl_add_u32 v20, v20, 2, v137
    s_mul_i32 s3, s31, 1280
    s_mul_i32 s66, s32, 640
    s_add_u32 s3, s3, s66
    s_lshl_b32 s66, s33, 7
    s_add_u32 s3, s3, s66
    s_lshl_b32 s66, s30, 5
    s_add_u32 s3, s3, s66
    v_add_lshl_u32 v148, v20, s3, 1
    v_mov_b32 v20, 0
    v_mov_b32 v21, 0
    v_mov_b32 v22, 0
    v_mov_b32 v23, 0
    v_mov_b32 v24, 0
    v_mov_b32 v25, 0
    v_mov_b32 v26, 0
    v_mov_b32 v27, 0
    v_mov_b32 v28, 0
    v_mov_b32 v29, 0
    v_mov_b32 v30, 0
    v_mov_b32 v31, 0
    v_mov_b32 v32, 0
    v_mov_b32 v33, 0
    v_mov_b32 v34, 0
    v_mov_b32 v35, 0
    s_waitcnt vmcnt(2)
    v_perm_b32 v16, v60, v60, v6
    v_perm_b32 v17, v60, v60, v7
    v_perm_b32 v18, v61, v61, v6
    v_perm_b32 v19, v61, v61, v7
    s_add_u32 s38, s36, 131072
    buffer_load_dwordx4 a[32:35], v3, s[12:15], s38 offen
    s_add_u32 s38, s36, 163840
    buffer_load_dwordx4 a[36:39], v3, s[12:15], s38 offen
    s_nop 0
    v_mfma_f32_4x4x4_16b_bf16 v[20:23], v[16:17], a[0:1], v[20:23] cbsz:2 abid:0
    v_mfma_f32_4x4x4_16b_bf16 v[24:27], v[16:17], a[2:3], v[24:27] cbsz:2 abid:0
    v_mfma_f32_4x4x4_16b_bf16 v[28:31], v[16:17], a[4:5], v[28:31] cbsz:2 abid:1
    v_mfma_f32_4x4x4_16b_bf16 v[32:35], v[16:17], a[6:7], v[32:35] cbsz:2 abid:1
    v_mfma_f32_4x4x4_16b_bf16 v[20:23], v[16:17], a[8:9], v[20:23] cbsz:2 abid:2
    v_mfma_f32_4x4x4_16b_bf16 v[24:27], v[16:17], a[10:11], v[24:27] cbsz:2 abid:2
    v_mfma_f32_4x4x4_16b_bf16 v[28:31], v[16:17], a[12:13], v[28:31] cbsz:2 abid:3
    v_mfma_f32_4x4x4_16b_bf16 v[32:35], v[16:17], a[14:15], v[32:35] cbsz:2 abid:3
    v_perm_b32 v16, v62, v62, v6
    v_perm_b32 v17, v62, v62, v7
    s_add_u32 s38, s36, 196608
    buffer_load_dwordx4 a[40:43], v3, s[12:15], s38 offen
    s_add_u32 s38, s36, 229376
    buffer_load_dwordx4 a[44:47], v3, s[12:15], s38 offen
    buffer_load_dwordx4 a[48:51], v1, s[4:7], s34 offen offset:0 nt
    buffer_load_dwordx4 a[52:55], v1, s[4:7], s34 offen offset:1024 nt
    buffer_load_dwordx4 a[56:59], v1, s[4:7], s34 offen offset:2048 nt
    buffer_load_dwordx4 a[60:63], v1, s[4:7], s34 offen offset:3072 nt
    s_add_u32 s34, s34, 16384
    s_add_u32 s38, s36, 262144
    buffer_load_dwordx4 a[64:67], v3, s[12:15], s38 offen
    s_add_u32 s38, s36, 294912
    buffer_load_dwordx4 a[68:71], v3, s[12:15], s38 offen
    s_waitcnt vmcnt(6)
    s_nop 0
    v_mfma_f32_4x4x4_16b_bf16 v[20:23], v[18:19], a[32:33], v[20:23] cbsz:2 abid:0
    v_mfma_f32_4x4x4_16b_bf16 v[24:27], v[18:19], a[34:35], v[24:27] cbsz:2 abid:0
    v_mfma_f32_4x4x4_16b_bf16 v[28:31], v[18:19], a[36:37], v[28:31] cbsz:2 abid:1
    v_mfma_f32_4x4x4_16b_bf16 v[32:35], v[18:19], a[38:39], v[32:35] cbsz:2 abid:1
    v_mfma_f32_4x4x4_16b_bf16 v[20:23], v[18:19], a[40:41], v[20:23] cbsz:2 abid:2
    v_mfma_f32_4x4x4_16b_bf16 v[24:27], v[18:19], a[42:43], v[24:27] cbsz:2 abid:2
    v_mfma_f32_4x4x4_16b_bf16 v[28:31], v[18:19], a[44:45], v[28:31] cbsz:2 abid:3
    v_mfma_f32_4x4x4_16b_bf16 v[32:35], v[18:19], a[46:47], v[32:35] cbsz:2 abid:3
    v_perm_b32 v18, v63, v63, v6
    v_perm_b32 v19, v63, v63, v7
    s_add_u32 s38, s36, 327680
    buffer_load_dwordx4 a[72:75], v3, s[12:15], s38 offen
    s_add_u32 s38, s36, 360448
    buffer_load_dwordx4 a[76:79], v3, s[12:15], s38 offen
    buffer_load_dwordx4 a[80:83], v1, s[4:7], s34 offen offset:0 nt
    buffer_load_dwordx4 a[84:87], v1, s[4:7], s34 offen offset:1024 nt
    buffer_load_dwordx4 a[88:91], v1, s[4:7], s34 offen offset:2048 nt
    s_waitcnt vmcnt(10)
    buffer_load_dwordx4 a[92:95], v1, s[4:7], s34 offen offset:3072 nt
    s_add_u32 s34, s34, 16384
    s_add_u32 s38, s36, 393216
    buffer_load_dwordx4 a[96:99], v3, s[12:15], s38 offen
    s_add_u32 s38, s36, 425984
    buffer_load_dwordx4 a[100:103], v3, s[12:15], s38 offen
    s_waitcnt vmcnt(6)
    s_nop 0
    v_mfma_f32_4x4x4_16b_bf16 v[20:23], v[16:17], a[64:65], v[20:23] cbsz:2 abid:0
    v_mfma_f32_4x4x4_16b_bf16 v[24:27], v[16:17], a[66:67], v[24:27] cbsz:2 abid:0
    v_mfma_f32_4x4x4_16b_bf16 v[28:31], v[16:17], a[68:69], v[28:31] cbsz:2 abid:1
    v_mfma_f32_4x4x4_16b_bf16 v[32:35], v[16:17], a[70:71], v[32:35] cbsz:2 abid:1
    v_mfma_f32_4x4x4_16b_bf16 v[20:23], v[16:17], a[72:73], v[20:23] cbsz:2 abid:2
    v_mfma_f32_4x4x4_16b_bf16 v[24:27], v[16:17], a[74:75], v[24:27] cbsz:2 abid:2
    v_mfma_f32_4x4x4_16b_bf16 v[28:31], v[16:17], a[76:77], v[28:31] cbsz:2 abid:3
    v_mfma_f32_4x4x4_16b_bf16 v[32:35], v[16:17], a[78:79], v[32:35] cbsz:2 abid:3
    v_perm_b32 v16, v64, v64, v6
    v_perm_b32 v17, v64, v64, v7
    s_add_u32 s38, s36, 458752
    buffer_load_dwordx4 a[104:107], v3, s[12:15], s38 offen
    s_add_u32 s38, s36, 491520
    buffer_load_dwordx4 a[108:111], v3, s[12:15], s38 offen
    buffer_load_dwordx4 a[112:115], v1, s[4:7], s34 offen offset:0 nt
    buffer_load_dwordx4 a[116:119], v1, s[4:7], s34 offen offset:1024 nt
    buffer_load_dwordx4 a[120:123], v1, s[4:7], s34 offen offset:2048 nt
    s_waitcnt vmcnt(10)
    buffer_load_dwordx4 a[124:127], v1, s[4:7], s34 offen offset:3072 nt
    s_add_u32 s34, s34, 16384
    s_add_u32 s38, s36, 524288
    buffer_load_dwordx4 a[128:131], v3, s[12:15], s38 offen
    s_add_u32 s38, s36, 557056
    buffer_load_dwordx4 a[132:135], v3, s[12:15], s38 offen
    s_waitcnt vmcnt(6)
    s_nop 0
    v_mfma_f32_4x4x4_16b_bf16 v[20:23], v[18:19], a[96:97], v[20:23] cbsz:2 abid:0
    v_mfma_f32_4x4x4_16b_bf16 v[24:27], v[18:19], a[98:99], v[24:27] cbsz:2 abid:0
    v_mfma_f32_4x4x4_16b_bf16 v[28:31], v[18:19], a[100:101], v[28:31] cbsz:2 abid:1
    v_mfma_f32_4x4x4_16b_bf16 v[32:35], v[18:19], a[102:103], v[32:35] cbsz:2 abid:1
    v_mfma_f32_4x4x4_16b_bf16 v[20:23], v[18:19], a[104:105], v[20:23] cbsz:2 abid:2
    v_mfma_f32_4x4x4_16b_bf16 v[24:27], v[18:19], a[106:107], v[24:27] cbsz:2 abid:2
    v_mfma_f32_4x4x4_16b_bf16 v[28:31], v[18:19], a[108:109], v[28:31] cbsz:2 abid:3
    v_mfma_f32_4x4x4_16b_bf16 v[32:35], v[18:19], a[110:111], v[32:35] cbsz:2 abid:3
    v_perm_b32 v18, v65, v65, v6
    v_perm_b32 v19, v65, v65, v7
    s_add_u32 s38, s36, 589824
    buffer_load_dwordx4 a[136:139], v3, s[12:15], s38 offen
    s_add_u32 s38, s36, 622592
    buffer_load_dwordx4 a[140:143], v3, s[12:15], s38 offen
    buffer_load_dwordx4 a[144:147], v1, s[4:7], s34 offen offset:0 nt
    buffer_load_dwordx4 a[148:151], v1, s[4:7], s34 offen offset:1024 nt
    buffer_load_dwordx4 a[152:155], v1, s[4:7], s34 offen offset:2048 nt
    s_waitcnt vmcnt(10)
    buffer_load_dwordx4 a[156:159], v1, s[4:7], s34 offen offset:3072 nt
    s_add_u32 s34, s34, 16384
    s_add_u32 s38, s36, 655360
    buffer_load_dwordx4 a[160:163], v3, s[12:15], s38 offen
    s_add_u32 s38, s36, 688128
    buffer_load_dwordx4 a[164:167], v3, s[12:15], s38 offen
    s_waitcnt vmcnt(6)
    s_nop 0
    v_mfma_f32_4x4x4_16b_bf16 v[20:23], v[16:17], a[128:129], v[20:23] cbsz:2 abid:0
    v_mfma_f32_4x4x4_16b_bf16 v[24:27], v[16:17], a[130:131], v[24:27] cbsz:2 abid:0
    v_mfma_f32_4x4x4_16b_bf16 v[28:31], v[16:17], a[132:133], v[28:31] cbsz:2 abid:1
    v_mfma_f32_4x4x4_16b_bf16 v[32:35], v[16:17], a[134:135], v[32:35] cbsz:2 abid:1
    v_mfma_f32_4x4x4_16b_bf16 v[20:23], v[16:17], a[136:137], v[20:23] cbsz:2 abid:2
    v_mfma_f32_4x4x4_16b_bf16 v[24:27], v[16:17], a[138:139], v[24:27] cbsz:2 abid:2
    v_mfma_f32_4x4x4_16b_bf16 v[28:31], v[16:17], a[140:141], v[28:31] cbsz:2 abid:3
    v_mfma_f32_4x4x4_16b_bf16 v[32:35], v[16:17], a[142:143], v[32:35] cbsz:2 abid:3
    v_perm_b32 v16, v66, v66, v6
    v_perm_b32 v17, v66, v66, v7
    s_add_u32 s38, s36, 720896
    buffer_load_dwordx4 a[168:171], v3, s[12:15], s38 offen
    s_add_u32 s38, s36, 753664
    buffer_load_dwordx4 a[172:175], v3, s[12:15], s38 offen
    buffer_load_dwordx4 a[176:179], v1, s[4:7], s34 offen offset:0 nt
    buffer_load_dwordx4 a[180:183], v1, s[4:7], s34 offen offset:1024 nt
    buffer_load_dwordx4 a[184:187], v1, s[4:7], s34 offen offset:2048 nt
    s_waitcnt vmcnt(10)
    buffer_load_dwordx4 a[188:191], v1, s[4:7], s34 offen offset:3072 nt
    s_add_u32 s34, s34, 16384
    s_add_u32 s38, s36, 786432
    buffer_load_dwordx4 a[192:195], v3, s[12:15], s38 offen
    s_add_u32 s38, s36, 819200
    buffer_load_dwordx4 a[196:199], v3, s[12:15], s38 offen
    s_waitcnt vmcnt(6)
    s_nop 0
    v_mfma_f32_4x4x4_16b_bf16 v[20:23], v[18:19], a[160:161], v[20:23] cbsz:2 abid:0
    v_mfma_f32_4x4x4_16b_bf16 v[24:27], v[18:19], a[162:163], v[24:27] cbsz:2 abid:0
    v_mfma_f32_4x4x4_16b_bf16 v[28:31], v[18:19], a[164:165], v[28:31] cbsz:2 abid:1
    v_mfma_f32_4x4x4_16b_bf16 v[32:35], v[18:19], a[166:167], v[32:35] cbsz:2 abid:1
    v_mfma_f32_4x4x4_16b_bf16 v[20:23], v[18:19], a[168:169], v[20:23] cbsz:2 abid:2
    v_mfma_f32_4x4x4_16b_bf16 v[24:27], v[18:19], a[170:171], v[24:27] cbsz:2 abid:2
    v_mfma_f32_4x4x4_16b_bf16 v[28:31], v[18:19], a[172:173], v[28:31] cbsz:2 abid:3
    v_mfma_f32_4x4x4_16b_bf16 v[32:35], v[18:19], a[174:175], v[32:35] cbsz:2 abid:3
    v_perm_b32 v18, v67, v67, v6
    v_perm_b32 v19, v67, v67, v7
    s_add_u32 s38, s36, 851968
    buffer_load_dwordx4 a[200:203], v3, s[12:15], s38 offen
    s_add_u32 s38, s36, 884736
    buffer_load_dwordx4 a[204:207], v3, s[12:15], s38 offen
    buffer_load_dwordx4 a[208:211], v1, s[4:7], s34 offen offset:0 nt
    buffer_load_dwordx4 a[212:215], v1, s[4:7], s34 offen offset:1024 nt
    buffer_load_dwordx4 a[216:219], v1, s[4:7], s34 offen offset:2048 nt
    s_waitcnt vmcnt(10)
    buffer_load_dwordx4 a[220:223], v1, s[4:7], s34 offen offset:3072 nt
    s_add_u32 s34, s34, 16384
    s_add_u32 s38, s36, 917504
    buffer_load_dwordx4 a[224:227], v3, s[12:15], s38 offen
    s_add_u32 s38, s36, 950272
    buffer_load_dwordx4 a[228:231], v3, s[12:15], s38 offen
    s_waitcnt vmcnt(6)
    s_nop 0
    v_mfma_f32_4x4x4_16b_bf16 v[20:23], v[16:17], a[192:193], v[20:23] cbsz:2 abid:0
    v_mfma_f32_4x4x4_16b_bf16 v[24:27], v[16:17], a[194:195], v[24:27] cbsz:2 abid:0
    v_mfma_f32_4x4x4_16b_bf16 v[28:31], v[16:17], a[196:197], v[28:31] cbsz:2 abid:1
    v_mfma_f32_4x4x4_16b_bf16 v[32:35], v[16:17], a[198:199], v[32:35] cbsz:2 abid:1
    v_mfma_f32_4x4x4_16b_bf16 v[20:23], v[16:17], a[200:201], v[20:23] cbsz:2 abid:2
    v_mfma_f32_4x4x4_16b_bf16 v[24:27], v[16:17], a[202:203], v[24:27] cbsz:2 abid:2
    v_mfma_f32_4x4x4_16b_bf16 v[28:31], v[16:17], a[204:205], v[28:31] cbsz:2 abid:3
    v_mfma_f32_4x4x4_16b_bf16 v[32:35], v[16:17], a[206:207], v[32:35] cbsz:2 abid:3
    v_perm_b32 v16, v68, v68, v6
    v_perm_b32 v17, v68, v68, v7
    s_add_u32 s38, s36, 983040
    buffer_load_dwordx4 a[232:235], v3, s[12:15], s38 offen
    s_add_u32 s38, s36, 1015808
    buffer_load_dwordx4 a[236:239], v3, s[12:15], s38 offen
    buffer_load_dwordx4 a[240:243], v1, s[4:7], s34 offen offset:0 nt
    buffer_load_dwordx4 a[244:247], v1, s[4:7], s34 offen offset:1024 nt
    buffer_load_dwordx4 a[248:251], v1, s[4:7], s34 offen offset:2048 nt
    s_waitcnt vmcnt(10)
    buffer_load_dwordx4 a[252:255], v1, s[4:7], s34 offen offset:3072 nt
    s_add_u32 s34, s34, 16384
    s_add_u32 s38, s36, 1048576
    buffer_load_dwordx4 v[176:179], v3, s[12:15], s38 offen
    s_add_u32 s38, s36, 1081344
    buffer_load_dwordx4 v[180:183], v3, s[12:15], s38 offen
    s_waitcnt vmcnt(6)
    s_nop 0
    v_mfma_f32_4x4x4_16b_bf16 v[20:23], v[18:19], a[224:225], v[20:23] cbsz:2 abid:0
    v_mfma_f32_4x4x4_16b_bf16 v[24:27], v[18:19], a[226:227], v[24:27] cbsz:2 abid:0
    v_mfma_f32_4x4x4_16b_bf16 v[28:31], v[18:19], a[228:229], v[28:31] cbsz:2 abid:1
    v_mfma_f32_4x4x4_16b_bf16 v[32:35], v[18:19], a[230:231], v[32:35] cbsz:2 abid:1
    v_mfma_f32_4x4x4_16b_bf16 v[20:23], v[18:19], a[232:233], v[20:23] cbsz:2 abid:2
    v_mfma_f32_4x4x4_16b_bf16 v[24:27], v[18:19], a[234:235], v[24:27] cbsz:2 abid:2
    v_mfma_f32_4x4x4_16b_bf16 v[28:31], v[18:19], a[236:237], v[28:31] cbsz:2 abid:3
    v_mfma_f32_4x4x4_16b_bf16 v[32:35], v[18:19], a[238:239], v[32:35] cbsz:2 abid:3
    v_perm_b32 v18, v69, v69, v6
    v_perm_b32 v19, v69, v69, v7
    s_add_u32 s38, s36, 1114112
    buffer_load_dwordx4 v[184:187], v3, s[12:15], s38 offen
    s_add_u32 s38, s36, 1146880
    buffer_load_dwordx4 v[188:191], v3, s[12:15], s38 offen
    buffer_load_dwordx4 v[192:195], v1, s[4:7], s34 offen offset:0 nt
    buffer_load_dwordx4 v[196:199], v1, s[4:7], s34 offen offset:1024 nt
    buffer_load_dwordx4 v[200:203], v1, s[4:7], s34 offen offset:2048 nt
    s_waitcnt vmcnt(10)
    buffer_load_dwordx4 v[204:207], v1, s[4:7], s34 offen offset:3072 nt
    s_add_u32 s34, s34, 16384
    s_add_u32 s38, s36, 1179648
    buffer_load_dwordx4 v[208:211], v3, s[12:15], s38 offen
    s_add_u32 s38, s36, 1212416
    buffer_load_dwordx4 v[212:215], v3, s[12:15], s38 offen
    s_waitcnt vmcnt(6)
    s_nop 0
    v_mfma_f32_4x4x4_16b_bf16 v[20:23], v[16:17], v[176:177], v[20:23] cbsz:2 abid:0
    v_mfma_f32_4x4x4_16b_bf16 v[24:27], v[16:17], v[178:179], v[24:27] cbsz:2 abid:0
    v_mfma_f32_4x4x4_16b_bf16 v[28:31], v[16:17], v[180:181], v[28:31] cbsz:2 abid:1
    v_mfma_f32_4x4x4_16b_bf16 v[32:35], v[16:17], v[182:183], v[32:35] cbsz:2 abid:1
    v_mfma_f32_4x4x4_16b_bf16 v[20:23], v[16:17], v[184:185], v[20:23] cbsz:2 abid:2
    v_mfma_f32_4x4x4_16b_bf16 v[24:27], v[16:17], v[186:187], v[24:27] cbsz:2 abid:2
    v_mfma_f32_4x4x4_16b_bf16 v[28:31], v[16:17], v[188:189], v[28:31] cbsz:2 abid:3
    v_mfma_f32_4x4x4_16b_bf16 v[32:35], v[16:17], v[190:191], v[32:35] cbsz:2 abid:3
    s_add_u32 s38, s36, 1245184
    buffer_load_dwordx4 v[216:219], v3, s[12:15], s38 offen
    s_add_u32 s38, s36, 1277952
    buffer_load_dwordx4 v[220:223], v3, s[12:15], s38 offen
    buffer_load_dwordx4 v[224:227], v1, s[4:7], s34 offen offset:0 nt
    buffer_load_dwordx4 v[228:231], v1, s[4:7], s34 offen offset:1024 nt
    buffer_load_dwordx4 v[232:235], v1, s[4:7], s34 offen offset:2048 nt
    s_waitcnt vmcnt(10)
    buffer_load_dwordx4 v[236:239], v1, s[4:7], s34 offen offset:3072 nt
    s_add_u32 s34, s34, 16384
    s_waitcnt vmcnt(10)
    buffer_load_dwordx4 a[0:3], v1, s[4:7], s34 offen offset:0 nt
    s_waitcnt vmcnt(10)
    buffer_load_dwordx4 a[4:7], v1, s[4:7], s34 offen offset:1024 nt
    s_waitcnt vmcnt(6)
    s_nop 0
    v_mfma_f32_4x4x4_16b_bf16 v[20:23], v[18:19], v[208:209], v[20:23] cbsz:2 abid:0
    v_mfma_f32_4x4x4_16b_bf16 v[24:27], v[18:19], v[210:211], v[24:27] cbsz:2 abid:0
    v_mfma_f32_4x4x4_16b_bf16 v[28:31], v[18:19], v[212:213], v[28:31] cbsz:2 abid:1
    v_mfma_f32_4x4x4_16b_bf16 v[32:35], v[18:19], v[214:215], v[32:35] cbsz:2 abid:1
    v_mfma_f32_4x4x4_16b_bf16 v[20:23], v[18:19], v[216:217], v[20:23] cbsz:2 abid:2
    v_mfma_f32_4x4x4_16b_bf16 v[24:27], v[18:19], v[218:219], v[24:27] cbsz:2 abid:2
    v_mfma_f32_4x4x4_16b_bf16 v[28:31], v[18:19], v[220:221], v[28:31] cbsz:2 abid:3
    v_mfma_f32_4x4x4_16b_bf16 v[32:35], v[18:19], v[222:223], v[32:35] cbsz:2 abid:3
    buffer_load_dwordx4 a[8:11], v1, s[4:7], s34 offen offset:2048 nt
    s_nop 4
    v_add_f32 v92, v20, v28
    v_add_f32 v96, v24, v32
    v_add_f32 v93, v21, v29
    v_add_f32 v97, v25, v33
    v_add_f32 v94, v22, v30
    v_add_f32 v98, v26, v34
    v_add_f32 v95, v23, v31
    v_add_f32 v99, v27, v35
    s_nop 1
    v_permlane32_swap_b32 v92, v96
    v_permlane32_swap_b32 v93, v97
    v_permlane32_swap_b32 v94, v98
    v_permlane32_swap_b32 v95, v99
    v_add_f32 v92, v92, v96
    v_add_f32 v93, v93, v97
    v_add_f32 v94, v94, v98
    v_add_f32 v95, v95, v99
    s_nop 0
    v_permlane16_swap_b32 v92, v94
    v_permlane16_swap_b32 v93, v95
    v_add_f32 v92, v92, v94
    v_add_f32 v93, v93, v95
    ds_write_b64 v136, v[92:93] offset:0
    v_mov_b32 v20, 0
    v_mov_b32 v21, 0
    v_mov_b32 v22, 0
    v_mov_b32 v23, 0
    v_mov_b32 v24, 0
    v_mov_b32 v25, 0
    v_mov_b32 v26, 0
    buffer_load_dwordx4 a[12:15], v1, s[4:7], s34 offen offset:3072 nt
    s_add_u32 s34, s34, 16384
    v_mov_b32 v27, 0
    v_mov_b32 v28, 0
    v_mov_b32 v29, 0
    v_mov_b32 v30, 0
    v_mov_b32 v31, 0
    v_mov_b32 v32, 0
    v_mov_b32 v33, 0
    v_mov_b32 v34, 0
    v_mov_b32 v35, 0
    s_waitcnt lgkmcnt(0)
    s_barrier
    ds_read_b128 v[60:63], v138 offset:0
    ds_read_b128 v[64:67], v138 offset:16
    ds_read_b128 v[68:71], v138 offset:512
    ds_read_b128 v[72:75], v138 offset:528
    ds_read_b128 v[76:79], v138 offset:1024
    ds_read_b128 v[80:83], v138 offset:1040
    ds_read_b128 v[84:87], v138 offset:1536
    ds_read_b128 v[88:91], v138 offset:1552
    s_cmp_ge_u32 s33, 5
    s_cbranch_scc1 L_noflag
    s_cmp_lg_u32 s30, 0
    s_cbranch_scc1 L_noflag
    s_mul_i32 s3, s49, 5
    s_add_u32 s3, s3, s33
    s_lshl_b32 s3, s3, 2
    v_mov_b32 v92, s3
    v_mov_b32 v93, 1
    v_cmp_eq_u32 vcc, 0, v0
    s_and_saveexec_b64 s[72:73], vcc
    global_store_dword v92, v93, s[26:27] sc1
    s_mov_b64 exec, s[72:73]
L_noflag:
    s_waitcnt lgkmcnt(0)
    v_add_f32 v60, v60, v68
    v_add_f32 v76, v76, v84
    v_add_f32 v61, v61, v69
    v_add_f32 v77, v77, v85
    v_add_f32 v62, v62, v70
    v_add_f32 v78, v78, v86
    v_add_f32 v63, v63, v71
    v_add_f32 v79, v79, v87
    v_add_f32 v64, v64, v72
    v_add_f32 v80, v80, v88
    v_add_f32 v65, v65, v73
    v_add_f32 v81, v81, v89
    v_add_f32 v66, v66, v74
    v_add_f32 v82, v82, v90
    v_add_f32 v67, v67, v75
    v_add_f32 v83, v83, v91
    v_add_f32 v60, v60, v76
    v_add_f32 v61, v61, v77
    v_add_f32 v62, v62, v78
    v_add_f32 v63, v63, v79
    v_add_f32 v64, v64, v80
    v_add_f32 v65, v65, v81
    v_add_f32 v66, v66, v82
    v_add_f32 v67, v67, v83
    v_cvt_pk_bf16_f32 v68, v60, v61
    v_cvt_pk_bf16_f32 v69, v62, v63
    v_cvt_pk_bf16_f32 v70, v64, v65
    v_cvt_pk_bf16_f32 v71, v66, v67
    v_cndmask_b32 v36, 0, v68, s[40:41]
    s_waitcnt vmcnt(7)
    buffer_load_dwordx4 a[32:35], v1, s[4:7], s34 offen offset:0 nt
    v_cndmask_b32 v37, 0, v69, s[40:41]
    v_cndmask_b32 v38, 0, v70, s[40:41]
    v_cndmask_b32 v39, 0, v71, s[40:41]
    v_cndmask_b32 v40, 0, v68, s[42:43]
    v_cndmask_b32 v41, 0, v69, s[42:43]
    v_cndmask_b32 v42, 0, v70, s[42:43]
    v_cndmask_b32 v43, 0, v71, s[42:43]
    v_cndmask_b32 v44, 0, v68, s[44:45]
    v_cndmask_b32 v45, 0, v69, s[44:45]
    v_cndmask_b32 v46, 0, v70, s[44:45]
    v_cndmask_b32 v47, 0, v71, s[44:45]
    v_cndmask_b32 v48, 0, v68, s[46:47]
    v_cndmask_b32 v49, 0, v69, s[46:47]
    v_cndmask_b32 v50, 0, v70, s[46:47]
    v_cndmask_b32 v51, 0, v71, s[46:47]
    s_nop 1
    s_waitcnt vmcnt(6)
    buffer_load_dwordx4 a[36:39], v1, s[4:7], s34 offen offset:1024 nt
    s_waitcnt vmcnt(6)
    buffer_load_dwordx4 a[40:43], v1, s[4:7], s34 offen offset:2048 nt
    v_mfma_f32_16x16x32_bf16 v[52:55], a[16:19], v[36:39], 0
    v_mfma_f32_16x16x32_bf16 v[52:55], a[20:23], v[40:43], v[52:55]
    v_mfma_f32_16x16x32_bf16 v[52:55], a[24:27], v[44:47], v[52:55]
    v_mfma_f32_16x16x32_bf16 v[52:55], a[28:31], v[48:51], v[52:55]
    s_waitcnt vmcnt(6)
    buffer_load_dwordx4 a[44:47], v1, s[4:7], s34 offen offset:3072 nt
    s_add_u32 s34, s34, 16384
    s_waitcnt vmcnt(6)
    buffer_load_dwordx4 a[64:67], v1, s[4:7], s34 offen offset:0 nt
    v_mfma_f32_16x16x32_bf16 v[56:59], a[48:51], v[36:39], 0
    v_mfma_f32_16x16x32_bf16 v[56:59], a[52:55], v[40:43], v[56:59]
    v_mfma_f32_16x16x32_bf16 v[56:59], a[56:59], v[44:47], v[56:59]
    v_mfma_f32_16x16x32_bf16 v[56:59], a[60:63], v[48:51], v[56:59]
    v_mov_b32_dpp v60, v52 quad_perm:[0,0,0,0] row_mask:0xf bank_mask:0xf
    v_mov_b32_dpp v92, v54 quad_perm:[2,2,2,2] row_mask:0xf bank_mask:0xf
    s_nop 0
    v_add_f32_dpp v60, v53, v60 quad_perm:[1,1,1,1] row_mask:0xf bank_mask:0xf
    v_add_f32_dpp v92, v55, v92 quad_perm:[3,3,3,3] row_mask:0xf bank_mask:0xf
    v_add_f32 v60, v60, v92
    s_waitcnt vmcnt(6)
    buffer_load_dwordx4 a[68:71], v1, s[4:7], s34 offen offset:1024 nt
    s_waitcnt vmcnt(6)
    buffer_load_dwordx4 a[72:75], v1, s[4:7], s34 offen offset:2048 nt
    v_mfma_f32_16x16x32_bf16 v[52:55], a[80:83], v[36:39], 0
    v_mfma_f32_16x16x32_bf16 v[52:55], a[84:87], v[40:43], v[52:55]
    v_mfma_f32_16x16x32_bf16 v[52:55], a[88:91], v[44:47], v[52:55]
    v_mfma_f32_16x16x32_bf16 v[52:55], a[92:95], v[48:51], v[52:55]
    v_mov_b32_dpp v61, v56 quad_perm:[0,0,0,0] row_mask:0xf bank_mask:0xf
    v_mov_b32_dpp v92, v58 quad_perm:[2,2,2,2] row_mask:0xf bank_mask:0xf
    s_nop 0
    v_add_f32_dpp v61, v57, v61 quad_perm:[1,1,1,1] row_mask:0xf bank_mask:0xf
    v_add_f32_dpp v92, v59, v92 quad_perm:[3,3,3,3] row_mask:0xf bank_mask:0xf
    v_add_f32 v61, v61, v92
    s_waitcnt vmcnt(6)
    buffer_load_dwordx4 a[76:79], v1, s[4:7], s34 offen offset:3072 nt
    s_add_u32 s34, s34, 16384
    s_waitcnt vmcnt(6)
    buffer_load_dwordx4 a[96:99], v1, s[4:7], s34 offen offset:0 nt
    v_mfma_f32_16x16x32_bf16 v[56:59], a[112:115], v[36:39], 0
    v_mfma_f32_16x16x32_bf16 v[56:59], a[116:119], v[40:43], v[56:59]
    v_mfma_f32_16x16x32_bf16 v[56:59], a[120:123], v[44:47], v[56:59]
    v_mfma_f32_16x16x32_bf16 v[56:59], a[124:127], v[48:51], v[56:59]
    v_mov_b32_dpp v62, v52 quad_perm:[0,0,0,0] row_mask:0xf bank_mask:0xf
    v_mov_b32_dpp v92, v54 quad_perm:[2,2,2,2] row_mask:0xf bank_mask:0xf
    s_nop 0
    v_add_f32_dpp v62, v53, v62 quad_perm:[1,1,1,1] row_mask:0xf bank_mask:0xf
    v_add_f32_dpp v92, v55, v92 quad_perm:[3,3,3,3] row_mask:0xf bank_mask:0xf
    v_add_f32 v62, v62, v92
    s_waitcnt vmcnt(6)
    buffer_load_dwordx4 a[100:103], v1, s[4:7], s34 offen offset:1024 nt
    s_waitcnt vmcnt(6)
    buffer_load_dwordx4 a[104:107], v1, s[4:7], s34 offen offset:2048 nt
    v_mfma_f32_16x16x32_bf16 v[52:55], a[144:147], v[36:39], 0
    v_mfma_f32_16x16x32_bf16 v[52:55], a[148:151], v[40:43], v[52:55]
    v_mfma_f32_16x16x32_bf16 v[52:55], a[152:155], v[44:47], v[52:55]
    v_mfma_f32_16x16x32_bf16 v[52:55], a[156:159], v[48:51], v[52:55]
    v_mov_b32_dpp v63, v56 quad_perm:[0,0,0,0] row_mask:0xf bank_mask:0xf
    v_mov_b32_dpp v92, v58 quad_perm:[2,2,2,2] row_mask:0xf bank_mask:0xf
    s_nop 0
    v_add_f32_dpp v63, v57, v63 quad_perm:[1,1,1,1] row_mask:0xf bank_mask:0xf
    v_add_f32_dpp v92, v59, v92 quad_perm:[3,3,3,3] row_mask:0xf bank_mask:0xf
    v_add_f32 v63, v63, v92
    s_waitcnt vmcnt(6)
    buffer_load_dwordx4 a[108:111], v1, s[4:7], s34 offen offset:3072 nt
    s_add_u32 s34, s34, 16384
    s_waitcnt vmcnt(6)
    buffer_load_dwordx4 a[128:131], v1, s[4:7], s34 offen offset:0 nt
    v_mfma_f32_16x16x32_bf16 v[56:59], a[176:179], v[36:39], 0
    v_mfma_f32_16x16x32_bf16 v[56:59], a[180:183], v[40:43], v[56:59]
    v_mfma_f32_16x16x32_bf16 v[56:59], a[184:187], v[44:47], v[56:59]
    v_mfma_f32_16x16x32_bf16 v[56:59], a[188:191], v[48:51], v[56:59]
    v_mov_b32_dpp v64, v52 quad_perm:[0,0,0,0] row_mask:0xf bank_mask:0xf
    v_mov_b32_dpp v92, v54 quad_perm:[2,2,2,2] row_mask:0xf bank_mask:0xf
    s_nop 0
    v_add_f32_dpp v64, v53, v64 quad_perm:[1,1,1,1] row_mask:0xf bank_mask:0xf
    v_add_f32_dpp v92, v55, v92 quad_perm:[3,3,3,3] row_mask:0xf bank_mask:0xf
    v_add_f32 v64, v64, v92
    s_waitcnt vmcnt(6)
    buffer_load_dwordx4 a[132:135], v1, s[4:7], s34 offen offset:1024 nt
    s_waitcnt vmcnt(6)
    buffer_load_dwordx4 a[136:139], v1, s[4:7], s34 offen offset:2048 nt
    v_mfma_f32_16x16x32_bf16 v[52:55], a[208:211], v[36:39], 0
    v_mfma_f32_16x16x32_bf16 v[52:55], a[212:215], v[40:43], v[52:55]
    v_mfma_f32_16x16x32_bf16 v[52:55], a[216:219], v[44:47], v[52:55]
    v_mfma_f32_16x16x32_bf16 v[52:55], a[220:223], v[48:51], v[52:55]
    v_mov_b32_dpp v65, v56 quad_perm:[0,0,0,0] row_mask:0xf bank_mask:0xf
    v_mov_b32_dpp v92, v58 quad_perm:[2,2,2,2] row_mask:0xf bank_mask:0xf
    s_nop 0
    v_add_f32_dpp v65, v57, v65 quad_perm:[1,1,1,1] row_mask:0xf bank_mask:0xf
    v_add_f32_dpp v92, v59, v92 quad_perm:[3,3,3,3] row_mask:0xf bank_mask:0xf
    v_add_f32 v65, v65, v92
    s_waitcnt vmcnt(6)
    buffer_load_dwordx4 a[140:143], v1, s[4:7], s34 offen offset:3072 nt
    s_add_u32 s34, s34, 16384
    s_waitcnt vmcnt(6)
    buffer_load_dwordx4 a[160:163], v1, s[4:7], s34 offen offset:0 nt
    v_mfma_f32_16x16x32_bf16 v[56:59], a[240:243], v[36:39], 0
    v_mfma_f32_16x16x32_bf16 v[56:59], a[244:247], v[40:43], v[56:59]
    v_mfma_f32_16x16x32_bf16 v[56:59], a[248:251], v[44:47], v[56:59]
    v_mfma_f32_16x16x32_bf16 v[56:59], a[252:255], v[48:51], v[56:59]
    v_mov_b32_dpp v66, v52 quad_perm:[0,0,0,0] row_mask:0xf bank_mask:0xf
    v_mov_b32_dpp v92, v54 quad_perm:[2,2,2,2] row_mask:0xf bank_mask:0xf
    s_nop 0
    v_add_f32_dpp v66, v53, v66 quad_perm:[1,1,1,1] row_mask:0xf bank_mask:0xf
    v_add_f32_dpp v92, v55, v92 quad_perm:[3,3,3,3] row_mask:0xf bank_mask:0xf
    v_add_f32 v66, v66, v92
    s_waitcnt vmcnt(6)
    buffer_load_dwordx4 a[164:167], v1, s[4:7], s34 offen offset:1024 nt
    s_waitcnt vmcnt(6)
    buffer_load_dwordx4 a[168:171], v1, s[4:7], s34 offen offset:2048 nt
    v_mfma_f32_16x16x32_bf16 v[52:55], v[192:195], v[36:39], 0
    v_mfma_f32_16x16x32_bf16 v[52:55], v[196:199], v[40:43], v[52:55]
    v_mfma_f32_16x16x32_bf16 v[52:55], v[200:203], v[44:47], v[52:55]
    v_mfma_f32_16x16x32_bf16 v[52:55], v[204:207], v[48:51], v[52:55]
    v_mov_b32_dpp v67, v56 quad_perm:[0,0,0,0] row_mask:0xf bank_mask:0xf
    v_mov_b32_dpp v92, v58 quad_perm:[2,2,2,2] row_mask:0xf bank_mask:0xf
    s_nop 0
    v_add_f32_dpp v67, v57, v67 quad_perm:[1,1,1,1] row_mask:0xf bank_mask:0xf
    v_add_f32_dpp v92, v59, v92 quad_perm:[3,3,3,3] row_mask:0xf bank_mask:0xf
    v_add_f32 v67, v67, v92
    s_waitcnt vmcnt(6)
    buffer_load_dwordx4 a[172:175], v1, s[4:7], s34 offen offset:3072 nt
    s_add_u32 s34, s34, 16384
    s_waitcnt vmcnt(6)
    buffer_load_dwordx4 a[192:195], v1, s[4:7], s34 offen offset:0 nt
    v_mfma_f32_16x16x32_bf16 v[56:59], v[224:227], v[36:39], 0
    v_mfma_f32_16x16x32_bf16 v[56:59], v[228:231], v[40:43], v[56:59]
    v_mfma_f32_16x16x32_bf16 v[56:59], v[232:235], v[44:47], v[56:59]
    v_mfma_f32_16x16x32_bf16 v[56:59], v[236:239], v[48:51], v[56:59]
    v_mov_b32_dpp v68, v52 quad_perm:[0,0,0,0] row_mask:0xf bank_mask:0xf
    v_mov_b32_dpp v92, v54 quad_perm:[2,2,2,2] row_mask:0xf bank_mask:0xf
    s_nop 0
    v_add_f32_dpp v68, v53, v68 quad_perm:[1,1,1,1] row_mask:0xf bank_mask:0xf
    v_add_f32_dpp v92, v55, v92 quad_perm:[3,3,3,3] row_mask:0xf bank_mask:0xf
    v_add_f32 v68, v68, v92
    s_waitcnt vmcnt(6)
    buffer_load_dwordx4 a[196:199], v1, s[4:7], s34 offen offset:1024 nt
    s_waitcnt vmcnt(6)
    buffer_load_dwordx4 a[200:203], v1, s[4:7], s34 offen offset:2048 nt
    v_mfma_f32_16x16x32_bf16 v[52:55], a[0:3], v[36:39], 0
    v_mfma_f32_16x16x32_bf16 v[52:55], a[4:7], v[40:43], v[52:55]
    v_mfma_f32_16x16x32_bf16 v[52:55], a[8:11], v[44:47], v[52:55]
    v_mfma_f32_16x16x32_bf16 v[52:55], a[12:15], v[48:51], v[52:55]
    v_mov_b32_dpp v69, v56 quad_perm:[0,0,0,0] row_mask:0xf bank_mask:0xf
    v_mov_b32_dpp v92, v58 quad_perm:[2,2,2,2] row_mask:0xf bank_mask:0xf
    s_nop 0
    v_add_f32_dpp v69, v57, v69 quad_perm:[1,1,1,1] row_mask:0xf bank_mask:0xf
    v_add_f32_dpp v92, v59, v92 quad_perm:[3,3,3,3] row_mask:0xf bank_mask:0xf
    v_add_f32 v69, v69, v92
    s_waitcnt vmcnt(6)
    buffer_load_dwordx4 a[204:207], v1, s[4:7], s34 offen offset:3072 nt
    s_add_u32 s34, s34, 16384
    s_waitcnt vmcnt(6)
    buffer_load_dwordx4 a[224:227], v1, s[4:7], s34 offen offset:0 nt
    v_mfma_f32_16x16x32_bf16 v[56:59], a[32:35], v[36:39], 0
    v_mfma_f32_16x16x32_bf16 v[56:59], a[36:39], v[40:43], v[56:59]
    v_mfma_f32_16x16x32_bf16 v[56:59], a[40:43], v[44:47], v[56:59]
    v_mfma_f32_16x16x32_bf16 v[56:59], a[44:47], v[48:51], v[56:59]
    v_mov_b32_dpp v70, v52 quad_perm:[0,0,0,0] row_mask:0xf bank_mask:0xf
    v_mov_b32_dpp v92, v54 quad_perm:[2,2,2,2] row_mask:0xf bank_mask:0xf
    s_nop 0
    v_add_f32_dpp v70, v53, v70 quad_perm:[1,1,1,1] row_mask:0xf bank_mask:0xf
    v_add_f32_dpp v92, v55, v92 quad_perm:[3,3,3,3] row_mask:0xf bank_mask:0xf
    v_add_f32 v70, v70, v92
    s_waitcnt vmcnt(6)
    buffer_load_dwordx4 a[228:231], v1, s[4:7], s34 offen offset:1024 nt
    s_waitcnt vmcnt(6)
    buffer_load_dwordx4 a[232:235], v1, s[4:7], s34 offen offset:2048 nt
    v_mfma_f32_16x16x32_bf16 v[52:55], a[64:67], v[36:39], 0
    v_mfma_f32_16x16x32_bf16 v[52:55], a[68:71], v[40:43], v[52:55]
    v_mfma_f32_16x16x32_bf16 v[52:55], a[72:75], v[44:47], v[52:55]
    v_mfma_f32_16x16x32_bf16 v[52:55], a[76:79], v[48:51], v[52:55]
    v_mov_b32_dpp v71, v56 quad_perm:[0,0,0,0] row_mask:0xf bank_mask:0xf
    v_mov_b32_dpp v92, v58 quad_perm:[2,2,2,2] row_mask:0xf bank_mask:0xf
    s_nop 0
    v_add_f32_dpp v71, v57, v71 quad_perm:[1,1,1,1] row_mask:0xf bank_mask:0xf
    v_add_f32_dpp v92, v59, v92 quad_perm:[3,3,3,3] row_mask:0xf bank_mask:0xf
    v_add_f32 v71, v71, v92
    s_waitcnt vmcnt(6)
    buffer_load_dwordx4 a[236:239], v1, s[4:7], s34 offen offset:3072 nt
    s_add_u32 s34, s34, 16384
    s_waitcnt vmcnt(6)
    buffer_load_dwordx4 v[176:179], v1, s[4:7], s34 offen offset:0 nt
    v_mfma_f32_16x16x32_bf16 v[56:59], a[96:99], v[36:39], 0
    v_mfma_f32_16x16x32_bf16 v[56:59], a[100:103], v[40:43], v[56:59]
    v_mfma_f32_16x16x32_bf16 v[56:59], a[104:107], v[44:47], v[56:59]
    v_mfma_f32_16x16x32_bf16 v[56:59], a[108:111], v[48:51], v[56:59]
    v_mov_b32_dpp v72, v52 quad_perm:[0,0,0,0] row_mask:0xf bank_mask:0xf
    v_mov_b32_dpp v92, v54 quad_perm:[2,2,2,2] row_mask:0xf bank_mask:0xf
    s_nop 0
    v_add_f32_dpp v72, v53, v72 quad_perm:[1,1,1,1] row_mask:0xf bank_mask:0xf
    v_add_f32_dpp v92, v55, v92 quad_perm:[3,3,3,3] row_mask:0xf bank_mask:0xf
    v_add_f32 v72, v72, v92
    s_waitcnt vmcnt(6)
    buffer_load_dwordx4 v[180:183], v1, s[4:7], s34 offen offset:1024 nt
    s_waitcnt vmcnt(6)
    buffer_load_dwordx4 v[184:187], v1, s[4:7], s34 offen offset:2048 nt
    v_mfma_f32_16x16x32_bf16 v[52:55], a[128:131], v[36:39], 0
    v_mfma_f32_16x16x32_bf16 v[52:55], a[132:135], v[40:43], v[52:55]
    v_mfma_f32_16x16x32_bf16 v[52:55], a[136:139], v[44:47], v[52:55]
    v_mfma_f32_16x16x32_bf16 v[52:55], a[140:143], v[48:51], v[52:55]
    v_mov_b32_dpp v73, v56 quad_perm:[0,0,0,0] row_mask:0xf bank_mask:0xf
    v_mov_b32_dpp v92, v58 quad_perm:[2,2,2,2] row_mask:0xf bank_mask:0xf
    s_nop 0
    v_add_f32_dpp v73, v57, v73 quad_perm:[1,1,1,1] row_mask:0xf bank_mask:0xf
    v_add_f32_dpp v92, v59, v92 quad_perm:[3,3,3,3] row_mask:0xf bank_mask:0xf
    v_add_f32 v73, v73, v92
    s_waitcnt vmcnt(6)
    buffer_load_dwordx4 v[188:191], v1, s[4:7], s34 offen offset:3072 nt
    s_add_u32 s34, s34, 16384
    s_waitcnt vmcnt(6)
    buffer_load_dwordx4 v[208:211], v1, s[4:7], s34 offen offset:0 nt
    v_mfma_f32_16x16x32_bf16 v[56:59], a[160:163], v[36:39], 0
    v_mfma_f32_16x16x32_bf16 v[56:59], a[164:167], v[40:43], v[56:59]
    v_mfma_f32_16x16x32_bf16 v[56:59], a[168:171], v[44:47], v[56:59]
    v_mfma_f32_16x16x32_bf16 v[56:59], a[172:175], v[48:51], v[56:59]
    v_mov_b32_dpp v74, v52 quad_perm:[0,0,0,0] row_mask:0xf bank_mask:0xf
    v_mov_b32_dpp v92, v54 quad_perm:[2,2,2,2] row_mask:0xf bank_mask:0xf
    s_nop 0
    v_add_f32_dpp v74, v53, v74 quad_perm:[1,1,1,1] row_mask:0xf bank_mask:0xf
    v_add_f32_dpp v92, v55, v92 quad_perm:[3,3,3,3] row_mask:0xf bank_mask:0xf
    v_add_f32 v74, v74, v92
    s_waitcnt vmcnt(6)
    buffer_load_dwordx4 v[212:215], v1, s[4:7], s34 offen offset:1024 nt
    s_waitcnt vmcnt(6)
    buffer_load_dwordx4 v[216:219], v1, s[4:7], s34 offen offset:2048 nt
    v_mfma_f32_16x16x32_bf16 v[52:55], a[192:195], v[36:39], 0
    v_mfma_f32_16x16x32_bf16 v[52:55], a[196:199], v[40:43], v[52:55]
    v_mfma_f32_16x16x32_bf16 v[52:55], a[200:203], v[44:47], v[52:55]
    v_mfma_f32_16x16x32_bf16 v[52:55], a[204:207], v[48:51], v[52:55]
    v_mov_b32_dpp v75, v56 quad_perm:[0,0,0,0] row_mask:0xf bank_mask:0xf
    v_mov_b32_dpp v92, v58 quad_perm:[2,2,2,2] row_mask:0xf bank_mask:0xf
    s_nop 0
    v_add_f32_dpp v75, v57, v75 quad_perm:[1,1,1,1] row_mask:0xf bank_mask:0xf
    v_add_f32_dpp v92, v59, v92 quad_perm:[3,3,3,3] row_mask:0xf bank_mask:0xf
    v_add_f32 v75, v75, v92
    s_waitcnt vmcnt(6)
    buffer_load_dwordx4 v[220:223], v1, s[4:7], s34 offen offset:3072 nt
    s_add_u32 s34, s34, 16384
    s_waitcnt vmcnt(6)
    buffer_load_dwordx4 a[16:19], v1, s[4:7], s34 offen offset:0 nt
    v_mfma_f32_16x16x32_bf16 v[56:59], a[224:227], v[36:39], 0
    v_mfma_f32_16x16x32_bf16 v[56:59], a[228:231], v[40:43], v[56:59]
    v_mfma_f32_16x16x32_bf16 v[56:59], a[232:235], v[44:47], v[56:59]
    v_mfma_f32_16x16x32_bf16 v[56:59], a[236:239], v[48:51], v[56:59]
    v_mov_b32_dpp v76, v52 quad_perm:[0,0,0,0] row_mask:0xf bank_mask:0xf
    v_mov_b32_dpp v92, v54 quad_perm:[2,2,2,2] row_mask:0xf bank_mask:0xf
    s_nop 0
    v_add_f32_dpp v76, v53, v76 quad_perm:[1,1,1,1] row_mask:0xf bank_mask:0xf
    v_add_f32_dpp v92, v55, v92 quad_perm:[3,3,3,3] row_mask:0xf bank_mask:0xf
    v_add_f32 v76, v76, v92
    s_waitcnt vmcnt(6)
    buffer_load_dwordx4 a[20:23], v1, s[4:7], s34 offen offset:1024 nt
    s_waitcnt vmcnt(6)
    buffer_load_dwordx4 a[24:27], v1, s[4:7], s34 offen offset:2048 nt
    v_mfma_f32_16x16x32_bf16 v[52:55], v[176:179], v[36:39], 0
    v_mfma_f32_16x16x32_bf16 v[52:55], v[180:183], v[40:43], v[52:55]
    v_mfma_f32_16x16x32_bf16 v[52:55], v[184:187], v[44:47], v[52:55]
    v_mfma_f32_16x16x32_bf16 v[52:55], v[188:191], v[48:51], v[52:55]
    v_mov_b32_dpp v77, v56 quad_perm:[0,0,0,0] row_mask:0xf bank_mask:0xf
    v_mov_b32_dpp v92, v58 quad_perm:[2,2,2,2] row_mask:0xf bank_mask:0xf
    s_nop 0
    v_add_f32_dpp v77, v57, v77 quad_perm:[1,1,1,1] row_mask:0xf bank_mask:0xf
    v_add_f32_dpp v92, v59, v92 quad_perm:[3,3,3,3] row_mask:0xf bank_mask:0xf
    v_add_f32 v77, v77, v92
    s_waitcnt vmcnt(6)
    buffer_load_dwordx4 a[28:31], v1, s[4:7], s34 offen offset:3072 nt
    s_add_u32 s34, s34, 16384
    s_waitcnt vmcnt(6)
    buffer_load_dwordx4 a[48:51], v1, s[4:7], s34 offen offset:0 nt
    s_waitcnt vmcnt(6)
    buffer_load_dwordx4 a[52:55], v1, s[4:7], s34 offen offset:1024 nt
    s_waitcnt vmcnt(6)
    buffer_load_dwordx4 a[56:59], v1, s[4:7], s34 offen offset:2048 nt
    v_mfma_f32_16x16x32_bf16 v[56:59], v[208:211], v[36:39], 0
    v_mfma_f32_16x16x32_bf16 v[56:59], v[212:215], v[40:43], v[56:59]
    v_mfma_f32_16x16x32_bf16 v[56:59], v[216:219], v[44:47], v[56:59]
    v_mfma_f32_16x16x32_bf16 v[56:59], v[220:223], v[48:51], v[56:59]
    v_mov_b32_dpp v78, v52 quad_perm:[0,0,0,0] row_mask:0xf bank_mask:0xf
    v_mov_b32_dpp v92, v54 quad_perm:[2,2,2,2] row_mask:0xf bank_mask:0xf
    s_nop 0
    v_add_f32_dpp v78, v53, v78 quad_perm:[1,1,1,1] row_mask:0xf bank_mask:0xf
    v_add_f32_dpp v92, v55, v92 quad_perm:[3,3,3,3] row_mask:0xf bank_mask:0xf
    v_add_f32 v78, v78, v92
    s_waitcnt vmcnt(6)
    buffer_load_dwordx4 a[60:63], v1, s[4:7], s34 offen offset:3072 nt
    s_add_u32 s34, s34, 16384
    s_waitcnt vmcnt(6)
    buffer_load_dwordx4 a[80:83], v1, s[4:7], s34 offen offset:0 nt
    s_waitcnt vmcnt(6)
    buffer_load_dwordx4 a[84:87], v1, s[4:7], s34 offen offset:1024 nt
    s_waitcnt vmcnt(6)
    buffer_load_dwordx4 a[88:91], v1, s[4:7], s34 offen offset:2048 nt
    v_mfma_f32_16x16x32_bf16 v[52:55], a[16:19], v[36:39], 0
    v_mfma_f32_16x16x32_bf16 v[52:55], a[20:23], v[40:43], v[52:55]
    v_mfma_f32_16x16x32_bf16 v[52:55], a[24:27], v[44:47], v[52:55]
    v_mfma_f32_16x16x32_bf16 v[52:55], a[28:31], v[48:51], v[52:55]
    v_mov_b32_dpp v79, v56 quad_perm:[0,0,0,0] row_mask:0xf bank_mask:0xf
    v_mov_b32_dpp v92, v58 quad_perm:[2,2,2,2] row_mask:0xf bank_mask:0xf
    s_nop 0
    v_add_f32_dpp v79, v57, v79 quad_perm:[1,1,1,1] row_mask:0xf bank_mask:0xf
    v_add_f32_dpp v92, v59, v92 quad_perm:[3,3,3,3] row_mask:0xf bank_mask:0xf
    v_add_f32 v79, v79, v92
    s_waitcnt vmcnt(6)
    buffer_load_dwordx4 a[92:95], v1, s[4:7], s34 offen offset:3072 nt
    s_add_u32 s34, s34, 16384
    s_waitcnt vmcnt(6)
    buffer_load_dwordx4 a[112:115], v1, s[4:7], s34 offen offset:0 nt
    s_waitcnt vmcnt(6)
    buffer_load_dwordx4 a[116:119], v1, s[4:7], s34 offen offset:1024 nt
    s_waitcnt vmcnt(6)
    buffer_load_dwordx4 a[120:123], v1, s[4:7], s34 offen offset:2048 nt
    v_mfma_f32_16x16x32_bf16 v[56:59], a[48:51], v[36:39], 0
    v_mfma_f32_16x16x32_bf16 v[56:59], a[52:55], v[40:43], v[56:59]
    v_mfma_f32_16x16x32_bf16 v[56:59], a[56:59], v[44:47], v[56:59]
    v_mfma_f32_16x16x32_bf16 v[56:59], a[60:63], v[48:51], v[56:59]
    v_mov_b32_dpp v80, v52 quad_perm:[0,0,0,0] row_mask:0xf bank_mask:0xf
    v_mov_b32_dpp v92, v54 quad_perm:[2,2,2,2] row_mask:0xf bank_mask:0xf
    s_nop 0
    v_add_f32_dpp v80, v53, v80 quad_perm:[1,1,1,1] row_mask:0xf bank_mask:0xf
    v_add_f32_dpp v92, v55, v92 quad_perm:[3,3,3,3] row_mask:0xf bank_mask:0xf
    v_add_f32 v80, v80, v92
    s_waitcnt vmcnt(6)
    buffer_load_dwordx4 a[124:127], v1, s[4:7], s34 offen offset:3072 nt
    s_add_u32 s34, s34, 16384
    s_waitcnt vmcnt(6)
    buffer_load_dwordx4 a[144:147], v1, s[4:7], s34 offen offset:0 nt
    s_waitcnt vmcnt(6)
    buffer_load_dwordx4 a[148:151], v1, s[4:7], s34 offen offset:1024 nt
    s_waitcnt vmcnt(6)
    buffer_load_dwordx4 a[152:155], v1, s[4:7], s34 offen offset:2048 nt
    v_mfma_f32_16x16x32_bf16 v[52:55], a[80:83], v[36:39], 0
    v_mfma_f32_16x16x32_bf16 v[52:55], a[84:87], v[40:43], v[52:55]
    v_mfma_f32_16x16x32_bf16 v[52:55], a[88:91], v[44:47], v[52:55]
    v_mfma_f32_16x16x32_bf16 v[52:55], a[92:95], v[48:51], v[52:55]
    v_mov_b32_dpp v81, v56 quad_perm:[0,0,0,0] row_mask:0xf bank_mask:0xf
    v_mov_b32_dpp v92, v58 quad_perm:[2,2,2,2] row_mask:0xf bank_mask:0xf
    s_nop 0
    v_add_f32_dpp v81, v57, v81 quad_perm:[1,1,1,1] row_mask:0xf bank_mask:0xf
    v_add_f32_dpp v92, v59, v92 quad_perm:[3,3,3,3] row_mask:0xf bank_mask:0xf
    v_add_f32 v81, v81, v92
    s_waitcnt vmcnt(6)
    buffer_load_dwordx4 a[156:159], v1, s[4:7], s34 offen offset:3072 nt
    s_add_u32 s34, s34, 16384
    s_waitcnt vmcnt(6)
    buffer_load_dwordx4 a[176:179], v1, s[4:7], s34 offen offset:0 nt
    s_waitcnt vmcnt(6)
    buffer_load_dwordx4 a[180:183], v1, s[4:7], s34 offen offset:1024 nt
    s_waitcnt vmcnt(6)
    buffer_load_dwordx4 a[184:187], v1, s[4:7], s34 offen offset:2048 nt
    v_mfma_f32_16x16x32_bf16 v[56:59], a[112:115], v[36:39], 0
    v_mfma_f32_16x16x32_bf16 v[56:59], a[116:119], v[40:43], v[56:59]
    v_mfma_f32_16x16x32_bf16 v[56:59], a[120:123], v[44:47], v[56:59]
    v_mfma_f32_16x16x32_bf16 v[56:59], a[124:127], v[48:51], v[56:59]
    v_mov_b32_dpp v82, v52 quad_perm:[0,0,0,0] row_mask:0xf bank_mask:0xf
    v_mov_b32_dpp v92, v54 quad_perm:[2,2,2,2] row_mask:0xf bank_mask:0xf
    s_nop 0
    v_add_f32_dpp v82, v53, v82 quad_perm:[1,1,1,1] row_mask:0xf bank_mask:0xf
    v_add_f32_dpp v92, v55, v92 quad_perm:[3,3,3,3] row_mask:0xf bank_mask:0xf
    v_add_f32 v82, v82, v92
    s_waitcnt vmcnt(6)
    buffer_load_dwordx4 a[188:191], v1, s[4:7], s34 offen offset:3072 nt
    s_add_u32 s34, s34, 16384
    s_waitcnt vmcnt(6)
    buffer_load_dwordx4 a[208:211], v1, s[4:7], s34 offen offset:0 nt
    s_waitcnt vmcnt(6)
    buffer_load_dwordx4 a[212:215], v1, s[4:7], s34 offen offset:1024 nt
    s_waitcnt vmcnt(6)
    buffer_load_dwordx4 a[216:219], v1, s[4:7], s34 offen offset:2048 nt
    v_mfma_f32_16x16x32_bf16 v[52:55], a[144:147], v[36:39], 0
    v_mfma_f32_16x16x32_bf16 v[52:55], a[148:151], v[40:43], v[52:55]
    v_mfma_f32_16x16x32_bf16 v[52:55], a[152:155], v[44:47], v[52:55]
    v_mfma_f32_16x16x32_bf16 v[52:55], a[156:159], v[48:51], v[52:55]
    v_mov_b32_dpp v83, v56 quad_perm:[0,0,0,0] row_mask:0xf bank_mask:0xf
    v_mov_b32_dpp v92, v58 quad_perm:[2,2,2,2] row_mask:0xf bank_mask:0xf
    s_nop 0
    v_add_f32_dpp v83, v57, v83 quad_perm:[1,1,1,1] row_mask:0xf bank_mask:0xf
    v_add_f32_dpp v92, v59, v92 quad_perm:[3,3,3,3] row_mask:0xf bank_mask:0xf
    v_add_f32 v83, v83, v92
    s_waitcnt vmcnt(6)
    buffer_load_dwordx4 a[220:223], v1, s[4:7], s34 offen offset:3072 nt
    s_add_u32 s34, s34, 16384
    s_waitcnt vmcnt(6)
    buffer_load_dwordx4 a[240:243], v1, s[4:7], s34 offen offset:0 nt
    s_waitcnt vmcnt(6)
    buffer_load_dwordx4 a[244:247], v1, s[4:7], s34 offen offset:1024 nt
    s_waitcnt vmcnt(6)
    buffer_load_dwordx4 a[248:251], v1, s[4:7], s34 offen offset:2048 nt
    v_mfma_f32_16x16x32_bf16 v[56:59], a[176:179], v[36:39], 0
    v_mfma_f32_16x16x32_bf16 v[56:59], a[180:183], v[40:43], v[56:59]
    v_mfma_f32_16x16x32_bf16 v[56:59], a[184:187], v[44:47], v[56:59]
    v_mfma_f32_16x16x32_bf16 v[56:59], a[188:191], v[48:51], v[56:59]
    v_mov_b32_dpp v84, v52 quad_perm:[0,0,0,0] row_mask:0xf bank_mask:0xf
    v_mov_b32_dpp v92, v54 quad_perm:[2,2,2,2] row_mask:0xf bank_mask:0xf
    s_nop 0
    v_add_f32_dpp v84, v53, v84 quad_perm:[1,1,1,1] row_mask:0xf bank_mask:0xf
    v_add_f32_dpp v92, v55, v92 quad_perm:[3,3,3,3] row_mask:0xf bank_mask:0xf
    v_add_f32 v84, v84, v92
    s_waitcnt vmcnt(6)
    buffer_load_dwordx4 a[252:255], v1, s[4:7], s34 offen offset:3072 nt
    s_add_u32 s34, s34, 16384
    s_waitcnt vmcnt(6)
    buffer_load_dwordx4 v[192:195], v1, s[4:7], s34 offen offset:0 nt
    s_waitcnt vmcnt(6)
    buffer_load_dwordx4 v[196:199], v1, s[4:7], s34 offen offset:1024 nt
    s_waitcnt vmcnt(6)
    buffer_load_dwordx4 v[200:203], v1, s[4:7], s34 offen offset:2048 nt
    v_mfma_f32_16x16x32_bf16 v[52:55], a[208:211], v[36:39], 0
    v_mfma_f32_16x16x32_bf16 v[52:55], a[212:215], v[40:43], v[52:55]
    v_mfma_f32_16x16x32_bf16 v[52:55], a[216:219], v[44:47], v[52:55]
    v_mfma_f32_16x16x32_bf16 v[52:55], a[220:223], v[48:51], v[52:55]
    v_mov_b32_dpp v85, v56 quad_perm:[0,0,0,0] row_mask:0xf bank_mask:0xf
    v_mov_b32_dpp v92, v58 quad_perm:[2,2,2,2] row_mask:0xf bank_mask:0xf
    s_nop 0
    v_add_f32_dpp v85, v57, v85 quad_perm:[1,1,1,1] row_mask:0xf bank_mask:0xf
    v_add_f32_dpp v92, v59, v92 quad_perm:[3,3,3,3] row_mask:0xf bank_mask:0xf
    v_add_f32 v85, v85, v92
    s_waitcnt vmcnt(6)
    buffer_load_dwordx4 v[204:207], v1, s[4:7], s34 offen offset:3072 nt
    s_add_u32 s34, s34, 16384
    s_waitcnt vmcnt(6)
    buffer_load_dwordx4 v[224:227], v1, s[4:7], s34 offen offset:0 nt
    s_waitcnt vmcnt(6)
    buffer_load_dwordx4 v[228:231], v1, s[4:7], s34 offen offset:1024 nt
    s_waitcnt vmcnt(6)
    buffer_load_dwordx4 v[232:235], v1, s[4:7], s34 offen offset:2048 nt
    v_mfma_f32_16x16x32_bf16 v[56:59], a[240:243], v[36:39], 0
    v_mfma_f32_16x16x32_bf16 v[56:59], a[244:247], v[40:43], v[56:59]
    v_mfma_f32_16x16x32_bf16 v[56:59], a[248:251], v[44:47], v[56:59]
    v_mfma_f32_16x16x32_bf16 v[56:59], a[252:255], v[48:51], v[56:59]
    v_mov_b32_dpp v86, v52 quad_perm:[0,0,0,0] row_mask:0xf bank_mask:0xf
    v_mov_b32_dpp v92, v54 quad_perm:[2,2,2,2] row_mask:0xf bank_mask:0xf
    s_nop 0
    v_add_f32_dpp v86, v53, v86 quad_perm:[1,1,1,1] row_mask:0xf bank_mask:0xf
    v_add_f32_dpp v92, v55, v92 quad_perm:[3,3,3,3] row_mask:0xf bank_mask:0xf
    v_add_f32 v86, v86, v92
    s_waitcnt vmcnt(6)
    buffer_load_dwordx4 v[236:239], v1, s[4:7], s34 offen offset:3072 nt
    s_add_u32 s34, s34, 16384
    s_waitcnt vmcnt(6)
    buffer_load_dwordx4 a[0:3], v1, s[4:7], s34 offen offset:0 nt
    s_waitcnt vmcnt(6)
    buffer_load_dwordx4 a[4:7], v1, s[4:7], s34 offen offset:1024 nt
    s_waitcnt vmcnt(6)
    buffer_load_dwordx4 a[8:11], v1, s[4:7], s34 offen offset:2048 nt
    v_mfma_f32_16x16x32_bf16 v[52:55], v[192:195], v[36:39], 0
    v_mfma_f32_16x16x32_bf16 v[52:55], v[196:199], v[40:43], v[52:55]
    v_mfma_f32_16x16x32_bf16 v[52:55], v[200:203], v[44:47], v[52:55]
    v_mfma_f32_16x16x32_bf16 v[52:55], v[204:207], v[48:51], v[52:55]
    v_mov_b32_dpp v87, v56 quad_perm:[0,0,0,0] row_mask:0xf bank_mask:0xf
    v_mov_b32_dpp v92, v58 quad_perm:[2,2,2,2] row_mask:0xf bank_mask:0xf
    s_nop 0
    v_add_f32_dpp v87, v57, v87 quad_perm:[1,1,1,1] row_mask:0xf bank_mask:0xf
    v_add_f32_dpp v92, v59, v92 quad_perm:[3,3,3,3] row_mask:0xf bank_mask:0xf
    v_add_f32 v87, v87, v92
    s_waitcnt vmcnt(6)
    buffer_load_dwordx4 a[12:15], v1, s[4:7], s34 offen offset:3072 nt
    s_add_u32 s34, s34, 16384
    s_waitcnt vmcnt(6)
    buffer_load_dwordx4 a[32:35], v1, s[4:7], s34 offen offset:0 nt
    s_waitcnt vmcnt(6)
    buffer_load_dwordx4 a[36:39], v1, s[4:7], s34 offen offset:1024 nt
    s_waitcnt vmcnt(6)
    buffer_load_dwordx4 a[40:43], v1, s[4:7], s34 offen offset:2048 nt
    v_mfma_f32_16x16x32_bf16 v[56:59], v[224:227], v[36:39], 0
    v_mfma_f32_16x16x32_bf16 v[56:59], v[228:231], v[40:43], v[56:59]
    v_mfma_f32_16x16x32_bf16 v[56:59], v[232:235], v[44:47], v[56:59]
    v_mfma_f32_16x16x32_bf16 v[56:59], v[236:239], v[48:51], v[56:59]
    v_mov_b32_dpp v88, v52 quad_perm:[0,0,0,0] row_mask:0xf bank_mask:0xf
    v_mov_b32_dpp v92, v54 quad_perm:[2,2,2,2] row_mask:0xf bank_mask:0xf
    s_nop 0
    v_add_f32_dpp v88, v53, v88 quad_perm:[1,1,1,1] row_mask:0xf bank_mask:0xf
    v_add_f32_dpp v92, v55, v92 quad_perm:[3,3,3,3] row_mask:0xf bank_mask:0xf
    v_add_f32 v88, v88, v92
    s_waitcnt vmcnt(6)
    buffer_load_dwordx4 a[44:47], v1, s[4:7], s34 offen offset:3072 nt
    s_waitcnt vmcnt(6)
    buffer_load_dwordx4 a[64:67], v2, s[8:11], s35 offen offset:0 nt
    s_waitcnt vmcnt(6)
    buffer_load_dwordx4 a[68:71], v2, s[8:11], s35 offen offset:1024 nt
    s_waitcnt vmcnt(6)
    buffer_load_dwordx4 a[72:75], v2, s[8:11], s35 offen offset:2048 nt
    v_mfma_f32_16x16x32_bf16 v[52:55], a[0:3], v[36:39], 0
    v_mfma_f32_16x16x32_bf16 v[52:55], a[4:7], v[40:43], v[52:55]
    v_mfma_f32_16x16x32_bf16 v[52:55], a[8:11], v[44:47], v[52:55]
    v_mfma_f32_16x16x32_bf16 v[52:55], a[12:15], v[48:51], v[52:55]
    v_mov_b32_dpp v89, v56 quad_perm:[0,0,0,0] row_mask:0xf bank_mask:0xf
    v_mov_b32_dpp v92, v58 quad_perm:[2,2,2,2] row_mask:0xf bank_mask:0xf
    s_nop 0
    v_add_f32_dpp v89, v57, v89 quad_perm:[1,1,1,1] row_mask:0xf bank_mask:0xf
    v_add_f32_dpp v92, v59, v92 quad_perm:[3,3,3,3] row_mask:0xf bank_mask:0xf
    v_add_f32 v89, v89, v92
    buffer_load_dwordx4 a[76:79], v2, s[8:11], s35 offen offset:3072 nt
    s_add_u32 s35, s35, 16384
    s_waitcnt vmcnt(7)
    buffer_load_dwordx4 a[96:99], v2, s[8:11], s35 offen offset:0 nt
    s_waitcnt vmcnt(7)
    buffer_load_dwordx4 a[100:103], v2, s[8:11], s35 offen offset:1024 nt
    s_waitcnt vmcnt(7)
    buffer_load_dwordx4 a[104:107], v2, s[8:11], s35 offen offset:2048 nt
    s_waitcnt vmcnt(7)
    buffer_load_dwordx4 a[108:111], v2, s[8:11], s35 offen offset:3072 nt
    s_add_u32 s35, s35, 16384
    v_mfma_f32_16x16x32_bf16 v[56:59], a[32:35], v[36:39], 0
    v_mfma_f32_16x16x32_bf16 v[56:59], a[36:39], v[40:43], v[56:59]
    v_mfma_f32_16x16x32_bf16 v[56:59], a[40:43], v[44:47], v[56:59]
    v_mfma_f32_16x16x32_bf16 v[56:59], a[44:47], v[48:51], v[56:59]
    v_mov_b32_dpp v90, v52 quad_perm:[0,0,0,0] row_mask:0xf bank_mask:0xf
    v_mov_b32_dpp v92, v54 quad_perm:[2,2,2,2] row_mask:0xf bank_mask:0xf
    s_nop 0
    v_add_f32_dpp v90, v53, v90 quad_perm:[1,1,1,1] row_mask:0xf bank_mask:0xf
    v_add_f32_dpp v92, v55, v92 quad_perm:[3,3,3,3] row_mask:0xf bank_mask:0xf
    v_add_f32 v90, v90, v92
    s_nop 7
    v_mov_b32_dpp v91, v56 quad_perm:[0,0,0,0] row_mask:0xf bank_mask:0xf
    v_mov_b32_dpp v92, v58 quad_perm:[2,2,2,2] row_mask:0xf bank_mask:0xf
    s_nop 0
    v_add_f32_dpp v91, v57, v91 quad_perm:[1,1,1,1] row_mask:0xf bank_mask:0xf
    v_add_f32_dpp v92, v59, v92 quad_perm:[3,3,3,3] row_mask:0xf bank_mask:0xf
    v_add_f32 v91, v91, v92
    v_max3_f32 v93, v60, v61, v62
    v_max3_f32 v94, v63, v64, v65
    v_max3_f32 v93, v93, v66, v67
    v_max3_f32 v94, v94, v68, v69
    v_max3_f32 v93, v93, v70, v71
    v_max3_f32 v94, v94, v72, v73
    v_max3_f32 v93, v93, v74, v75
    v_max3_f32 v94, v94, v76, v77
    v_max3_f32 v93, v93, v78, v79
    v_max3_f32 v94, v94, v80, v81
    v_max3_f32 v93, v93, v82, v83
    v_max3_f32 v94, v94, v84, v85
    v_max3_f32 v93, v93, v86, v87
    v_max3_f32 v94, v94, v88, v89
    v_max3_f32 v93, v93, v90, v91
    v_max_f32 v93, v93, v94
    s_nop 1
    v_max_f32_dpp v93, v93, v93 row_ror:4 row_mask:0xf bank_mask:0xf
    s_nop 1
    v_max_f32_dpp v93, v93, v93 row_ror:8 row_mask:0xf bank_mask:0xf
    v_mov_b32 v94, v93
    s_nop 1
    v_permlane16_swap_b32 v93, v94
    v_max_f32 v93, v93, v94
    v_mov_b32 v94, v93
    s_nop 1
    v_permlane32_swap_b32 v93, v94
    v_max_f32 v93, v93, v94
    v_mul_f32 v96, s48, v93
    v_fma_f32 v60, v60, s48, -v96
    s_waitcnt vmcnt(7)
    buffer_load_dwordx4 a[128:131], v2, s[8:11], s35 offen offset:0 nt
    v_fma_f32 v61, v61, s48, -v96
    v_fma_f32 v62, v62, s48, -v96
    v_fma_f32 v63, v63, s48, -v96
    v_fma_f32 v64, v64, s48, -v96
    v_fma_f32 v65, v65, s48, -v96
    v_fma_f32 v66, v66, s48, -v96
    v_fma_f32 v67, v67, s48, -v96
    v_fma_f32 v68, v68, s48, -v96
    v_fma_f32 v69, v69, s48, -v96
    v_fma_f32 v70, v70, s48, -v96
    v_fma_f32 v71, v71, s48, -v96
    v_fma_f32 v72, v72, s48, -v96
    v_fma_f32 v73, v73, s48, -v96
    v_fma_f32 v74, v74, s48, -v96
    v_fma_f32 v75, v75, s48, -v96
    v_fma_f32 v76, v76, s48, -v96
    v_fma_f32 v77, v77, s48, -v96
    v_fma_f32 v78, v78, s48, -v96
    v_fma_f32 v79, v79, s48, -v96
    v_fma_f32 v80, v80, s48, -v96
    v_fma_f32 v81, v81, s48, -v96
    v_fma_f32 v82, v82, s48, -v96
    v_fma_f32 v83, v83, s48, -v96
    v_fma_f32 v84, v84, s48, -v96
    v_fma_f32 v85, v85, s48, -v96
    v_fma_f32 v86, v86, s48, -v96
    v_fma_f32 v87, v87, s48, -v96
    v_fma_f32 v88, v88, s48, -v96
    v_fma_f32 v89, v89, s48, -v96
    v_fma_f32 v90, v90, s48, -v96
    s_waitcnt vmcnt(7)
    buffer_load_dwordx4 a[132:135], v2, s[8:11], s35 offen offset:1024 nt
    v_fma_f32 v91, v91, s48, -v96
    v_exp_f32 v60, v60
    v_exp_f32 v61, v61
    v_exp_f32 v62, v62
    v_exp_f32 v63, v63
    v_exp_f32 v64, v64
    v_exp_f32 v65, v65
    v_exp_f32 v66, v66
    v_exp_f32 v67, v67
    v_exp_f32 v68, v68
    v_exp_f32 v69, v69
    v_exp_f32 v70, v70
    v_exp_f32 v71, v71
    v_exp_f32 v72, v72
    v_exp_f32 v73, v73
    v_exp_f32 v74, v74
    v_exp_f32 v75, v75
    v_exp_f32 v76, v76
    v_exp_f32 v77, v77
    v_exp_f32 v78, v78
    v_exp_f32 v79, v79
    v_exp_f32 v80, v80
    v_exp_f32 v81, v81
    v_exp_f32 v82, v82
    v_exp_f32 v83, v83
    v_exp_f32 v84, v84
    v_exp_f32 v85, v85
    v_exp_f32 v86, v86
    v_exp_f32 v87, v87
    v_exp_f32 v88, v88
    s_waitcnt vmcnt(7)
    buffer_load_dwordx4 a[136:139], v2, s[8:11], s35 offen offset:2048 nt
    v_exp_f32 v89, v89
    v_exp_f32 v90, v90
    v_exp_f32 v91, v91
    v_add_f32 v97, v60, v61
    v_add_f32 v98, v62, v63
    v_add_f32 v97, v97, v64
    v_add_f32 v98, v98, v65
    v_add_f32 v97, v97, v66
    v_add_f32 v98, v98, v67
    v_add_f32 v97, v97, v68
    v_add_f32 v98, v98, v69
    v_add_f32 v97, v97, v70
    v_add_f32 v98, v98, v71
    v_add_f32 v97, v97, v72
    v_add_f32 v98, v98, v73
    v_add_f32 v97, v97, v74
    v_add_f32 v98, v98, v75
    v_add_f32 v97, v97, v76
    v_add_f32 v98, v98, v77
    v_add_f32 v97, v97, v78
    v_add_f32 v98, v98, v79
    v_add_f32 v97, v97, v80
    v_add_f32 v98, v98, v81
    v_add_f32 v97, v97, v82
    v_add_f32 v98, v98, v83
    v_add_f32 v97, v97, v84
    v_add_f32 v98, v98, v85
    v_add_f32 v97, v97, v86
    v_add_f32 v98, v98, v87
    v_add_f32 v97, v97, v88
    s_waitcnt vmcnt(7)
    buffer_load_dwordx4 a[140:143], v2, s[8:11], s35 offen offset:3072 nt
    s_add_u32 s35, s35, 16384
    v_add_f32 v98, v98, v89
    v_add_f32 v97, v97, v90
    v_add_f32 v98, v98, v91
    v_add_f32 v97, v97, v98
    s_nop 1
    v_add_f32_dpp v97, v97, v97 row_ror:4 row_mask:0xf bank_mask:0xf
    s_nop 1
    v_add_f32_dpp v97, v97, v97 row_ror:8 row_mask:0xf bank_mask:0xf
    v_mov_b32 v94, v97
    s_nop 1
    v_permlane16_swap_b32 v97, v94
    v_add_f32 v97, v97, v94
    v_mov_b32 v94, v97
    s_nop 1
    v_permlane32_swap_b32 v97, v94
    v_add_f32 v97, v97, v94
    s_lshl_b32 s3, s30, 3
    v_mov_b32 v94, s3
    v_mov_b32 v100, v96
    v_mov_b32 v101, v97
    ds_write_b64 v94, v[100:101] offset:2048
    s_waitcnt lgkmcnt(0)
    s_barrier
    v_mov_b32 v94, 0
    ds_read_b128 v[104:107], v94 offset:2048
    ds_read_b128 v[108:111], v94 offset:2064
    s_waitcnt lgkmcnt(0)
    v_max3_f32 v112, v104, v106, v108
    v_max_f32 v112, v112, v110
    v_sub_f32 v104, v104, v112
    s_waitcnt vmcnt(7)
    buffer_load_dwordx4 a[160:163], v2, s[8:11], s35 offen offset:0 nt
    v_sub_f32 v106, v106, v112
    v_sub_f32 v108, v108, v112
    v_sub_f32 v110, v110, v112
    v_exp_f32 v104, v104
    v_exp_f32 v106, v106
    v_exp_f32 v108, v108
    v_exp_f32 v110, v110
    s_nop 0
    v_mul_f32 v113, v104, v105
    v_fmac_f32 v113, v106, v107
    v_fmac_f32 v113, v108, v109
    v_fmac_f32 v113, v110, v111
    v_sub_f32 v114, v96, v112
    v_exp_f32 v114, v114
    v_rcp_f32 v113, v113
    s_nop 0
    v_mul_f32 v114, v114, v113
    v_mul_f32 v60, v60, v114
    v_mul_f32 v61, v61, v114
    v_mul_f32 v62, v62, v114
    v_mul_f32 v63, v63, v114
    v_mul_f32 v64, v64, v114
    v_mul_f32 v65, v65, v114
    v_mul_f32 v66, v66, v114
    v_mul_f32 v67, v67, v114
    v_mul_f32 v68, v68, v114
    v_mul_f32 v69, v69, v114
    v_mul_f32 v70, v70, v114
    v_mul_f32 v71, v71, v114
    v_mul_f32 v72, v72, v114
    s_waitcnt vmcnt(7)
    buffer_load_dwordx4 a[164:167], v2, s[8:11], s35 offen offset:1024 nt
    v_mul_f32 v73, v73, v114
    v_mul_f32 v74, v74, v114
    v_mul_f32 v75, v75, v114
    v_mul_f32 v76, v76, v114
    v_mul_f32 v77, v77, v114
    v_mul_f32 v78, v78, v114
    v_mul_f32 v79, v79, v114
    v_mul_f32 v80, v80, v114
    v_mul_f32 v81, v81, v114
    v_mul_f32 v82, v82, v114
    v_mul_f32 v83, v83, v114
    v_mul_f32 v84, v84, v114
    v_mul_f32 v85, v85, v114
    v_mul_f32 v86, v86, v114
    v_mul_f32 v87, v87, v114
    v_mul_f32 v88, v88, v114
    v_mul_f32 v89, v89, v114
    v_mul_f32 v90, v90, v114
    v_mul_f32 v91, v91, v114
    v_cvt_pk_bf16_f32 v60, v60, v61
    v_cvt_pk_bf16_f32 v61, v62, v63
    v_cvt_pk_bf16_f32 v62, v64, v65
    v_cvt_pk_bf16_f32 v63, v66, v67
    v_cvt_pk_bf16_f32 v64, v68, v69
    v_cvt_pk_bf16_f32 v65, v70, v71
    v_cvt_pk_bf16_f32 v66, v72, v73
    v_cvt_pk_bf16_f32 v67, v74, v75
    v_cvt_pk_bf16_f32 v68, v76, v77
    v_cvt_pk_bf16_f32 v69, v78, v79
    v_cvt_pk_bf16_f32 v70, v80, v81
    s_waitcnt vmcnt(7)
    buffer_load_dwordx4 a[168:171], v2, s[8:11], s35 offen offset:2048 nt
    v_cvt_pk_bf16_f32 v71, v82, v83
    v_cvt_pk_bf16_f32 v72, v84, v85
    v_cvt_pk_bf16_f32 v73, v86, v87
    v_cvt_pk_bf16_f32 v74, v88, v89
    v_cvt_pk_bf16_f32 v75, v90, v91
    v_perm_b32 v16, v60, v60, v6
    v_perm_b32 v17, v60, v60, v7
    v_perm_b32 v18, v60, v60, v8
    v_perm_b32 v19, v60, v60, v9
    s_nop 0
    v_mfma_f32_4x4x4_16b_bf16 v[20:23], v[16:17], a[64:65], v[20:23] cbsz:2 abid:0
    v_mfma_f32_4x4x4_16b_bf16 v[24:27], v[16:17], a[66:67], v[24:27] cbsz:2 abid:0
    v_mfma_f32_4x4x4_16b_bf16 v[28:31], v[16:17], a[68:69], v[28:31] cbsz:2 abid:1
    v_mfma_f32_4x4x4_16b_bf16 v[32:35], v[16:17], a[70:71], v[32:35] cbsz:2 abid:1
    v_mfma_f32_4x4x4_16b_bf16 v[20:23], v[16:17], a[72:73], v[20:23] cbsz:2 abid:2
    v_mfma_f32_4x4x4_16b_bf16 v[24:27], v[16:17], a[74:75], v[24:27] cbsz:2 abid:2
    v_mfma_f32_4x4x4_16b_bf16 v[28:31], v[16:17], a[76:77], v[28:31] cbsz:2 abid:3
    v_mfma_f32_4x4x4_16b_bf16 v[32:35], v[16:17], a[78:79], v[32:35] cbsz:2 abid:3
    v_perm_b32 v16, v61, v61, v6
    v_perm_b32 v17, v61, v61, v7
    s_waitcnt vmcnt(7)
    s_nop 0
    v_mfma_f32_4x4x4_16b_bf16 v[20:23], v[18:19], a[96:97], v[20:23] cbsz:2 abid:0
    v_mfma_f32_4x4x4_16b_bf16 v[24:27], v[18:19], a[98:99], v[24:27] cbsz:2 abid:0
    v_mfma_f32_4x4x4_16b_bf16 v[28:31], v[18:19], a[100:101], v[28:31] cbsz:2 abid:1
    v_mfma_f32_4x4x4_16b_bf16 v[32:35], v[18:19], a[102:103], v[32:35] cbsz:2 abid:1
    v_mfma_f32_4x4x4_16b_bf16 v[20:23], v[18:19], a[104:105], v[20:23] cbsz:2 abid:2
    v_mfma_f32_4x4x4_16b_bf16 v[24:27], v[18:19], a[106:107], v[24:27] cbsz:2 abid:2
    v_mfma_f32_4x4x4_16b_bf16 v[28:31], v[18:19], a[108:109], v[28:31] cbsz:2 abid:3
    v_mfma_f32_4x4x4_16b_bf16 v[32:35], v[18:19], a[110:111], v[32:35] cbsz:2 abid:3
    v_perm_b32 v18, v61, v61, v8
    v_perm_b32 v19, v61, v61, v9
    s_waitcnt vmcnt(6)
    buffer_load_dwordx4 a[172:175], v2, s[8:11], s35 offen offset:3072 nt
    s_add_u32 s35, s35, 16384
    s_waitcnt vmcnt(6)
    buffer_load_dwordx4 a[192:195], v2, s[8:11], s35 offen offset:0 nt
    s_waitcnt vmcnt(6)
    buffer_load_dwordx4 a[196:199], v2, s[8:11], s35 offen offset:1024 nt
    s_waitcnt vmcnt(6)
    buffer_load_dwordx4 a[200:203], v2, s[8:11], s35 offen offset:2048 nt
    s_nop 0
    v_mfma_f32_4x4x4_16b_bf16 v[20:23], v[16:17], a[128:129], v[20:23] cbsz:2 abid:0
    v_mfma_f32_4x4x4_16b_bf16 v[24:27], v[16:17], a[130:131], v[24:27] cbsz:2 abid:0
    v_mfma_f32_4x4x4_16b_bf16 v[28:31], v[16:17], a[132:133], v[28:31] cbsz:2 abid:1
    v_mfma_f32_4x4x4_16b_bf16 v[32:35], v[16:17], a[134:135], v[32:35] cbsz:2 abid:1
    v_mfma_f32_4x4x4_16b_bf16 v[20:23], v[16:17], a[136:137], v[20:23] cbsz:2 abid:2
    v_mfma_f32_4x4x4_16b_bf16 v[24:27], v[16:17], a[138:139], v[24:27] cbsz:2 abid:2
    v_mfma_f32_4x4x4_16b_bf16 v[28:31], v[16:17], a[140:141], v[28:31] cbsz:2 abid:3
    v_mfma_f32_4x4x4_16b_bf16 v[32:35], v[16:17], a[142:143], v[32:35] cbsz:2 abid:3
    v_perm_b32 v16, v62, v62, v6
    v_perm_b32 v17, v62, v62, v7
    s_waitcnt vmcnt(6)
    buffer_load_dwordx4 a[204:207], v2, s[8:11], s35 offen offset:3072 nt
    s_add_u32 s35, s35, 16384
    s_waitcnt vmcnt(6)
    buffer_load_dwordx4 a[224:227], v2, s[8:11], s35 offen offset:0 nt
    s_waitcnt vmcnt(6)
    buffer_load_dwordx4 a[228:231], v2, s[8:11], s35 offen offset:1024 nt
    s_waitcnt vmcnt(6)
    buffer_load_dwordx4 a[232:235], v2, s[8:11], s35 offen offset:2048 nt
    s_nop 0
    v_mfma_f32_4x4x4_16b_bf16 v[20:23], v[18:19], a[160:161], v[20:23] cbsz:2 abid:0
    v_mfma_f32_4x4x4_16b_bf16 v[24:27], v[18:19], a[162:163], v[24:27] cbsz:2 abid:0
    v_mfma_f32_4x4x4_16b_bf16 v[28:31], v[18:19], a[164:165], v[28:31] cbsz:2 abid:1
    v_mfma_f32_4x4x4_16b_bf16 v[32:35], v[18:19], a[166:167], v[32:35] cbsz:2 abid:1
    v_mfma_f32_4x4x4_16b_bf16 v[20:23], v[18:19], a[168:169], v[20:23] cbsz:2 abid:2
    v_mfma_f32_4x4x4_16b_bf16 v[24:27], v[18:19], a[170:171], v[24:27] cbsz:2 abid:2
    v_mfma_f32_4x4x4_16b_bf16 v[28:31], v[18:19], a[172:173], v[28:31] cbsz:2 abid:3
    v_mfma_f32_4x4x4_16b_bf16 v[32:35], v[18:19], a[174:175], v[32:35] cbsz:2 abid:3
    v_perm_b32 v18, v62, v62, v8
    v_perm_b32 v19, v62, v62, v9
    s_waitcnt vmcnt(6)
    buffer_load_dwordx4 a[236:239], v2, s[8:11], s35 offen offset:3072 nt
    s_add_u32 s35, s35, 16384
    s_waitcnt vmcnt(6)
    buffer_load_dwordx4 v[176:179], v2, s[8:11], s35 offen offset:0 nt
    s_waitcnt vmcnt(6)
    buffer_load_dwordx4 v[180:183], v2, s[8:11], s35 offen offset:1024 nt
    s_waitcnt vmcnt(6)
    buffer_load_dwordx4 v[184:187], v2, s[8:11], s35 offen offset:2048 nt
    s_nop 0
    v_mfma_f32_4x4x4_16b_bf16 v[20:23], v[16:17], a[192:193], v[20:23] cbsz:2 abid:0
    v_mfma_f32_4x4x4_16b_bf16 v[24:27], v[16:17], a[194:195], v[24:27] cbsz:2 abid:0
    v_mfma_f32_4x4x4_16b_bf16 v[28:31], v[16:17], a[196:197], v[28:31] cbsz:2 abid:1
    v_mfma_f32_4x4x4_16b_bf16 v[32:35], v[16:17], a[198:199], v[32:35] cbsz:2 abid:1
    v_mfma_f32_4x4x4_16b_bf16 v[20:23], v[16:17], a[200:201], v[20:23] cbsz:2 abid:2
    v_mfma_f32_4x4x4_16b_bf16 v[24:27], v[16:17], a[202:203], v[24:27] cbsz:2 abid:2
    v_mfma_f32_4x4x4_16b_bf16 v[28:31], v[16:17], a[204:205], v[28:31] cbsz:2 abid:3
    v_mfma_f32_4x4x4_16b_bf16 v[32:35], v[16:17], a[206:207], v[32:35] cbsz:2 abid:3
    v_perm_b32 v16, v63, v63, v6
    v_perm_b32 v17, v63, v63, v7
    s_waitcnt vmcnt(6)
    buffer_load_dwordx4 v[188:191], v2, s[8:11], s35 offen offset:3072 nt
    s_add_u32 s35, s35, 16384
    s_waitcnt vmcnt(6)
    buffer_load_dwordx4 v[208:211], v2, s[8:11], s35 offen offset:0 nt
    s_waitcnt vmcnt(6)
    buffer_load_dwordx4 v[212:215], v2, s[8:11], s35 offen offset:1024 nt
    s_waitcnt vmcnt(6)
    buffer_load_dwordx4 v[216:219], v2, s[8:11], s35 offen offset:2048 nt
    s_nop 0
    v_mfma_f32_4x4x4_16b_bf16 v[20:23], v[18:19], a[224:225], v[20:23] cbsz:2 abid:0
    v_mfma_f32_4x4x4_16b_bf16 v[24:27], v[18:19], a[226:227], v[24:27] cbsz:2 abid:0
    v_mfma_f32_4x4x4_16b_bf16 v[28:31], v[18:19], a[228:229], v[28:31] cbsz:2 abid:1
    v_mfma_f32_4x4x4_16b_bf16 v[32:35], v[18:19], a[230:231], v[32:35] cbsz:2 abid:1
    v_mfma_f32_4x4x4_16b_bf16 v[20:23], v[18:19], a[232:233], v[20:23] cbsz:2 abid:2
    v_mfma_f32_4x4x4_16b_bf16 v[24:27], v[18:19], a[234:235], v[24:27] cbsz:2 abid:2
    v_mfma_f32_4x4x4_16b_bf16 v[28:31], v[18:19], a[236:237], v[28:31] cbsz:2 abid:3
    v_mfma_f32_4x4x4_16b_bf16 v[32:35], v[18:19], a[238:239], v[32:35] cbsz:2 abid:3
    v_perm_b32 v18, v63, v63, v8
    v_perm_b32 v19, v63, v63, v9
    s_waitcnt vmcnt(6)
    buffer_load_dwordx4 v[220:223], v2, s[8:11], s35 offen offset:3072 nt
    s_add_u32 s35, s35, 16384
    s_waitcnt vmcnt(6)
    buffer_load_dwordx4 a[16:19], v2, s[8:11], s35 offen offset:0 nt
    s_add_u32 s39, s37, 0
    buffer_load_dwordx4 a[20:23], v2, s[16:19], s39 offen offset:0
    s_waitcnt vmcnt(7)
    buffer_load_dwordx4 a[24:27], v2, s[8:11], s35 offen offset:1024 nt
    s_waitcnt vmcnt(7)
    buffer_load_dwordx4 a[28:31], v2, s[8:11], s35 offen offset:2048 nt
    s_nop 0
    v_mfma_f32_4x4x4_16b_bf16 v[20:23], v[16:17], v[176:177], v[20:23] cbsz:2 abid:0
    v_mfma_f32_4x4x4_16b_bf16 v[24:27], v[16:17], v[178:179], v[24:27] cbsz:2 abid:0
    v_mfma_f32_4x4x4_16b_bf16 v[28:31], v[16:17], v[180:181], v[28:31] cbsz:2 abid:1
    v_mfma_f32_4x4x4_16b_bf16 v[32:35], v[16:17], v[182:183], v[32:35] cbsz:2 abid:1
    v_mfma_f32_4x4x4_16b_bf16 v[20:23], v[16:17], v[184:185], v[20:23] cbsz:2 abid:2
    v_mfma_f32_4x4x4_16b_bf16 v[24:27], v[16:17], v[186:187], v[24:27] cbsz:2 abid:2
    v_mfma_f32_4x4x4_16b_bf16 v[28:31], v[16:17], v[188:189], v[28:31] cbsz:2 abid:3
    v_mfma_f32_4x4x4_16b_bf16 v[32:35], v[16:17], v[190:191], v[32:35] cbsz:2 abid:3
    v_perm_b32 v16, v64, v64, v6
    v_perm_b32 v17, v64, v64, v7
    buffer_load_dwordx4 a[48:51], v2, s[16:19], s39 offen offset:1280
    s_waitcnt vmcnt(8)
    buffer_load_dwordx4 a[52:55], v2, s[8:11], s35 offen offset:3072 nt
    s_add_u32 s35, s35, 16384
    s_waitcnt vmcnt(8)
    buffer_load_dwordx4 a[56:59], v2, s[8:11], s35 offen offset:0 nt
    buffer_load_dwordx4 a[60:63], v2, s[16:19], s39 offen offset:2560
    s_waitcnt vmcnt(9)
    buffer_load_dwordx4 a[80:83], v2, s[8:11], s35 offen offset:1024 nt
    s_waitcnt vmcnt(9)
    buffer_load_dwordx4 a[84:87], v2, s[8:11], s35 offen offset:2048 nt
    s_nop 0
    v_mfma_f32_4x4x4_16b_bf16 v[20:23], v[18:19], v[208:209], v[20:23] cbsz:2 abid:0
    v_mfma_f32_4x4x4_16b_bf16 v[24:27], v[18:19], v[210:211], v[24:27] cbsz:2 abid:0
    v_mfma_f32_4x4x4_16b_bf16 v[28:31], v[18:19], v[212:213], v[28:31] cbsz:2 abid:1
    v_mfma_f32_4x4x4_16b_bf16 v[32:35], v[18:19], v[214:215], v[32:35] cbsz:2 abid:1
    v_mfma_f32_4x4x4_16b_bf16 v[20:23], v[18:19], v[216:217], v[20:23] cbsz:2 abid:2
    v_mfma_f32_4x4x4_16b_bf16 v[24:27], v[18:19], v[218:219], v[24:27] cbsz:2 abid:2
    v_mfma_f32_4x4x4_16b_bf16 v[28:31], v[18:19], v[220:221], v[28:31] cbsz:2 abid:3
    v_mfma_f32_4x4x4_16b_bf16 v[32:35], v[18:19], v[222:223], v[32:35] cbsz:2 abid:3
    v_perm_b32 v18, v64, v64, v8
    v_perm_b32 v19, v64, v64, v9
    buffer_load_dwordx4 a[88:91], v2, s[16:19], s39 offen offset:3840
    s_waitcnt vmcnt(10)
    buffer_load_dwordx4 a[92:95], v2, s[8:11], s35 offen offset:3072 nt
    s_add_u32 s35, s35, 16384
    s_waitcnt vmcnt(9)
    buffer_load_dwordx4 a[112:115], v2, s[8:11], s35 offen offset:0 nt
    buffer_load_dwordx4 a[116:119], v4, s[16:19], s39 offen offset:1024
    s_waitcnt vmcnt(10)
    buffer_load_dwordx4 a[120:123], v2, s[8:11], s35 offen offset:1024 nt
    s_waitcnt vmcnt(9)
    buffer_load_dwordx4 a[124:127], v2, s[8:11], s35 offen offset:2048 nt
    s_nop 0
    v_mfma_f32_4x4x4_16b_bf16 v[20:23], v[16:17], a[16:17], v[20:23] cbsz:2 abid:0
    v_mfma_f32_4x4x4_16b_bf16 v[24:27], v[16:17], a[18:19], v[24:27] cbsz:2 abid:0
    v_mfma_f32_4x4x4_16b_bf16 v[28:31], v[16:17], a[24:25], v[28:31] cbsz:2 abid:1
    v_mfma_f32_4x4x4_16b_bf16 v[32:35], v[16:17], a[26:27], v[32:35] cbsz:2 abid:1
    v_mfma_f32_4x4x4_16b_bf16 v[20:23], v[16:17], a[28:29], v[20:23] cbsz:2 abid:2
    v_mfma_f32_4x4x4_16b_bf16 v[24:27], v[16:17], a[30:31], v[24:27] cbsz:2 abid:2
    v_mfma_f32_4x4x4_16b_bf16 v[28:31], v[16:17], a[52:53], v[28:31] cbsz:2 abid:3
    v_mfma_f32_4x4x4_16b_bf16 v[32:35], v[16:17], a[54:55], v[32:35] cbsz:2 abid:3
    v_perm_b32 v16, v65, v65, v6
    v_perm_b32 v17, v65, v65, v7
    s_add_u32 s39, s37, 5120
    buffer_load_dwordx4 a[144:147], v2, s[16:19], s39 offen offset:0
    s_waitcnt vmcnt(10)
    buffer_load_dwordx4 a[148:151], v2, s[8:11], s35 offen offset:3072 nt
    s_add_u32 s35, s35, 16384
    s_waitcnt vmcnt(9)
    buffer_load_dwordx4 a[152:155], v2, s[8:11], s35 offen offset:0 nt
    buffer_load_dwordx4 a[156:159], v2, s[16:19], s39 offen offset:1280
    s_waitcnt vmcnt(10)
    buffer_load_dwordx4 a[176:179], v2, s[8:11], s35 offen offset:1024 nt
    s_waitcnt vmcnt(9)
    buffer_load_dwordx4 a[180:183], v2, s[8:11], s35 offen offset:2048 nt
    s_nop 0
    v_mfma_f32_4x4x4_16b_bf16 v[20:23], v[18:19], a[56:57], v[20:23] cbsz:2 abid:0
    v_mfma_f32_4x4x4_16b_bf16 v[24:27], v[18:19], a[58:59], v[24:27] cbsz:2 abid:0
    v_mfma_f32_4x4x4_16b_bf16 v[28:31], v[18:19], a[80:81], v[28:31] cbsz:2 abid:1
    v_mfma_f32_4x4x4_16b_bf16 v[32:35], v[18:19], a[82:83], v[32:35] cbsz:2 abid:1
    v_mfma_f32_4x4x4_16b_bf16 v[20:23], v[18:19], a[84:85], v[20:23] cbsz:2 abid:2
    v_mfma_f32_4x4x4_16b_bf16 v[24:27], v[18:19], a[86:87], v[24:27] cbsz:2 abid:2
    v_mfma_f32_4x4x4_16b_bf16 v[28:31], v[18:19], a[92:93], v[28:31] cbsz:2 abid:3
    v_mfma_f32_4x4x4_16b_bf16 v[32:35], v[18:19], a[94:95], v[32:35] cbsz:2 abid:3
    v_perm_b32 v18, v65, v65, v8
    v_perm_b32 v19, v65, v65, v9
    buffer_load_dwordx4 a[184:187], v2, s[16:19], s39 offen offset:2560
    s_waitcnt vmcnt(10)
    buffer_load_dwordx4 a[188:191], v2, s[8:11], s35 offen offset:3072 nt
    s_add_u32 s35, s35, 16384
    s_waitcnt vmcnt(9)
    buffer_load_dwordx4 a[208:211], v2, s[8:11], s35 offen offset:0 nt
    buffer_load_dwordx4 a[212:215], v2, s[16:19], s39 offen offset:3840
    s_waitcnt vmcnt(10)
    buffer_load_dwordx4 a[216:219], v2, s[8:11], s35 offen offset:1024 nt
    s_waitcnt vmcnt(9)
    buffer_load_dwordx4 a[220:223], v2, s[8:11], s35 offen offset:2048 nt
    s_nop 0
    v_mfma_f32_4x4x4_16b_bf16 v[20:23], v[16:17], a[112:113], v[20:23] cbsz:2 abid:0
    v_mfma_f32_4x4x4_16b_bf16 v[24:27], v[16:17], a[114:115], v[24:27] cbsz:2 abid:0
    v_mfma_f32_4x4x4_16b_bf16 v[28:31], v[16:17], a[120:121], v[28:31] cbsz:2 abid:1
    v_mfma_f32_4x4x4_16b_bf16 v[32:35], v[16:17], a[122:123], v[32:35] cbsz:2 abid:1
    v_mfma_f32_4x4x4_16b_bf16 v[20:23], v[16:17], a[124:125], v[20:23] cbsz:2 abid:2
    v_mfma_f32_4x4x4_16b_bf16 v[24:27], v[16:17], a[126:127], v[24:27] cbsz:2 abid:2
    v_mfma_f32_4x4x4_16b_bf16 v[28:31], v[16:17], a[148:149], v[28:31] cbsz:2 abid:3
    v_mfma_f32_4x4x4_16b_bf16 v[32:35], v[16:17], a[150:151], v[32:35] cbsz:2 abid:3
    v_perm_b32 v16, v66, v66, v6
    v_perm_b32 v17, v66, v66, v7
    buffer_load_dwordx4 a[240:243], v4, s[16:19], s39 offen offset:1024
    s_waitcnt vmcnt(10)
    buffer_load_dwordx4 a[244:247], v2, s[8:11], s35 offen offset:3072 nt
    s_add_u32 s35, s35, 16384
    s_waitcnt vmcnt(9)
    buffer_load_dwordx4 a[248:251], v2, s[8:11], s35 offen offset:0 nt
    s_add_u32 s39, s37, 10240
    buffer_load_dwordx4 a[252:255], v2, s[16:19], s39 offen offset:0
    s_waitcnt vmcnt(10)
    buffer_load_dwordx4 v[192:195], v2, s[8:11], s35 offen offset:1024 nt
    s_waitcnt vmcnt(9)
    buffer_load_dwordx4 v[196:199], v2, s[8:11], s35 offen offset:2048 nt
    s_nop 0
    v_mfma_f32_4x4x4_16b_bf16 v[20:23], v[18:19], a[152:153], v[20:23] cbsz:2 abid:0
    v_mfma_f32_4x4x4_16b_bf16 v[24:27], v[18:19], a[154:155], v[24:27] cbsz:2 abid:0
    v_mfma_f32_4x4x4_16b_bf16 v[28:31], v[18:19], a[176:177], v[28:31] cbsz:2 abid:1
    v_mfma_f32_4x4x4_16b_bf16 v[32:35], v[18:19], a[178:179], v[32:35] cbsz:2 abid:1
    v_mfma_f32_4x4x4_16b_bf16 v[20:23], v[18:19], a[180:181], v[20:23] cbsz:2 abid:2
    v_mfma_f32_4x4x4_16b_bf16 v[24:27], v[18:19], a[182:183], v[24:27] cbsz:2 abid:2
    v_mfma_f32_4x4x4_16b_bf16 v[28:31], v[18:19], a[188:189], v[28:31] cbsz:2 abid:3
    v_mfma_f32_4x4x4_16b_bf16 v[32:35], v[18:19], a[190:191], v[32:35] cbsz:2 abid:3
    v_perm_b32 v18, v66, v66, v8
    v_perm_b32 v19, v66, v66, v9
    buffer_load_dwordx4 v[200:203], v2, s[16:19], s39 offen offset:1280
    s_waitcnt vmcnt(10)
    buffer_load_dwordx4 v[204:207], v2, s[8:11], s35 offen offset:3072 nt
    s_add_u32 s35, s35, 16384
    s_waitcnt vmcnt(9)
    buffer_load_dwordx4 v[224:227], v2, s[8:11], s35 offen offset:0 nt
    buffer_load_dwordx4 v[228:231], v2, s[16:19], s39 offen offset:2560
    s_waitcnt vmcnt(10)
    buffer_load_dwordx4 v[232:235], v2, s[8:11], s35 offen offset:1024 nt
    s_waitcnt vmcnt(9)
    buffer_load_dwordx4 v[236:239], v2, s[8:11], s35 offen offset:2048 nt
    s_nop 0
    v_mfma_f32_4x4x4_16b_bf16 v[20:23], v[16:17], a[208:209], v[20:23] cbsz:2 abid:0
    v_mfma_f32_4x4x4_16b_bf16 v[24:27], v[16:17], a[210:211], v[24:27] cbsz:2 abid:0
    v_mfma_f32_4x4x4_16b_bf16 v[28:31], v[16:17], a[216:217], v[28:31] cbsz:2 abid:1
    v_mfma_f32_4x4x4_16b_bf16 v[32:35], v[16:17], a[218:219], v[32:35] cbsz:2 abid:1
    v_mfma_f32_4x4x4_16b_bf16 v[20:23], v[16:17], a[220:221], v[20:23] cbsz:2 abid:2
    v_mfma_f32_4x4x4_16b_bf16 v[24:27], v[16:17], a[222:223], v[24:27] cbsz:2 abid:2
    v_mfma_f32_4x4x4_16b_bf16 v[28:31], v[16:17], a[244:245], v[28:31] cbsz:2 abid:3
    v_mfma_f32_4x4x4_16b_bf16 v[32:35], v[16:17], a[246:247], v[32:35] cbsz:2 abid:3
    v_perm_b32 v16, v67, v67, v6
    v_perm_b32 v17, v67, v67, v7
    buffer_load_dwordx4 a[0:3], v2, s[16:19], s39 offen offset:3840
    s_waitcnt vmcnt(10)
    buffer_load_dwordx4 a[4:7], v2, s[8:11], s35 offen offset:3072 nt
    s_add_u32 s35, s35, 16384
    s_waitcnt vmcnt(9)
    buffer_load_dwordx4 a[8:11], v2, s[8:11], s35 offen offset:0 nt
    buffer_load_dwordx4 a[12:15], v4, s[16:19], s39 offen offset:1024
    s_waitcnt vmcnt(10)
    buffer_load_dwordx4 a[32:35], v2, s[8:11], s35 offen offset:1024 nt
    s_waitcnt vmcnt(9)
    buffer_load_dwordx4 a[36:39], v2, s[8:11], s35 offen offset:2048 nt
    s_nop 0
    v_mfma_f32_4x4x4_16b_bf16 v[20:23], v[18:19], a[248:249], v[20:23] cbsz:2 abid:0
    v_mfma_f32_4x4x4_16b_bf16 v[24:27], v[18:19], a[250:251], v[24:27] cbsz:2 abid:0
    v_mfma_f32_4x4x4_16b_bf16 v[28:31], v[18:19], v[192:193], v[28:31] cbsz:2 abid:1
    v_mfma_f32_4x4x4_16b_bf16 v[32:35], v[18:19], v[194:195], v[32:35] cbsz:2 abid:1
    v_mfma_f32_4x4x4_16b_bf16 v[20:23], v[18:19], v[196:197], v[20:23] cbsz:2 abid:2
    v_mfma_f32_4x4x4_16b_bf16 v[24:27], v[18:19], v[198:199], v[24:27] cbsz:2 abid:2
    v_mfma_f32_4x4x4_16b_bf16 v[28:31], v[18:19], v[204:205], v[28:31] cbsz:2 abid:3
    v_mfma_f32_4x4x4_16b_bf16 v[32:35], v[18:19], v[206:207], v[32:35] cbsz:2 abid:3
    v_perm_b32 v18, v67, v67, v8
    v_perm_b32 v19, v67, v67, v9
    s_add_u32 s39, s37, 15360
    buffer_load_dwordx4 a[40:43], v2, s[16:19], s39 offen offset:0
    s_waitcnt vmcnt(10)
    buffer_load_dwordx4 a[44:47], v2, s[8:11], s35 offen offset:3072 nt
    s_add_u32 s35, s35, 16384
    s_waitcnt vmcnt(9)
    buffer_load_dwordx4 a[64:67], v2, s[8:11], s35 offen offset:0 nt
    buffer_load_dwordx4 a[68:71], v2, s[16:19], s39 offen offset:1280
    s_waitcnt vmcnt(10)
    buffer_load_dwordx4 a[72:75], v2, s[8:11], s35 offen offset:1024 nt
    s_waitcnt vmcnt(9)
    buffer_load_dwordx4 a[76:79], v2, s[8:11], s35 offen offset:2048 nt
    s_nop 0
    v_mfma_f32_4x4x4_16b_bf16 v[20:23], v[16:17], v[224:225], v[20:23] cbsz:2 abid:0
    v_mfma_f32_4x4x4_16b_bf16 v[24:27], v[16:17], v[226:227], v[24:27] cbsz:2 abid:0
    v_mfma_f32_4x4x4_16b_bf16 v[28:31], v[16:17], v[232:233], v[28:31] cbsz:2 abid:1
    v_mfma_f32_4x4x4_16b_bf16 v[32:35], v[16:17], v[234:235], v[32:35] cbsz:2 abid:1
    v_mfma_f32_4x4x4_16b_bf16 v[20:23], v[16:17], v[236:237], v[20:23] cbsz:2 abid:2
    v_mfma_f32_4x4x4_16b_bf16 v[24:27], v[16:17], v[238:239], v[24:27] cbsz:2 abid:2
    v_mfma_f32_4x4x4_16b_bf16 v[28:31], v[16:17], a[4:5], v[28:31] cbsz:2 abid:3
    v_mfma_f32_4x4x4_16b_bf16 v[32:35], v[16:17], a[6:7], v[32:35] cbsz:2 abid:3
    v_perm_b32 v16, v68, v68, v6
    v_perm_b32 v17, v68, v68, v7
    buffer_load_dwordx4 a[96:99], v2, s[16:19], s39 offen offset:2560
    s_waitcnt vmcnt(10)
    buffer_load_dwordx4 a[100:103], v2, s[8:11], s35 offen offset:3072 nt
    s_add_u32 s35, s35, 16384
    s_waitcnt vmcnt(9)
    buffer_load_dwordx4 a[104:107], v2, s[8:11], s35 offen offset:0 nt
    buffer_load_dwordx4 a[108:111], v2, s[16:19], s39 offen offset:3840
    s_waitcnt vmcnt(10)
    buffer_load_dwordx4 a[128:131], v2, s[8:11], s35 offen offset:1024 nt
    s_waitcnt vmcnt(9)
    buffer_load_dwordx4 a[132:135], v2, s[8:11], s35 offen offset:2048 nt
    s_nop 0
    v_mfma_f32_4x4x4_16b_bf16 v[20:23], v[18:19], a[8:9], v[20:23] cbsz:2 abid:0
    v_mfma_f32_4x4x4_16b_bf16 v[24:27], v[18:19], a[10:11], v[24:27] cbsz:2 abid:0
    v_mfma_f32_4x4x4_16b_bf16 v[28:31], v[18:19], a[32:33], v[28:31] cbsz:2 abid:1
    v_mfma_f32_4x4x4_16b_bf16 v[32:35], v[18:19], a[34:35], v[32:35] cbsz:2 abid:1
    v_mfma_f32_4x4x4_16b_bf16 v[20:23], v[18:19], a[36:37], v[20:23] cbsz:2 abid:2
    v_mfma_f32_4x4x4_16b_bf16 v[24:27], v[18:19], a[38:39], v[24:27] cbsz:2 abid:2
    v_mfma_f32_4x4x4_16b_bf16 v[28:31], v[18:19], a[44:45], v[28:31] cbsz:2 abid:3
    v_mfma_f32_4x4x4_16b_bf16 v[32:35], v[18:19], a[46:47], v[32:35] cbsz:2 abid:3
    v_perm_b32 v18, v68, v68, v8
    v_perm_b32 v19, v68, v68, v9
    buffer_load_dwordx4 a[136:139], v4, s[16:19], s39 offen offset:1024
    s_waitcnt vmcnt(10)
    buffer_load_dwordx4 a[140:143], v2, s[8:11], s35 offen offset:3072 nt
    s_add_u32 s35, s35, 16384
    s_waitcnt vmcnt(9)
    buffer_load_dwordx4 a[160:163], v2, s[8:11], s35 offen offset:0 nt
    s_add_u32 s39, s37, 20480
    buffer_load_dwordx4 a[164:167], v2, s[16:19], s39 offen offset:0
    s_waitcnt vmcnt(10)
    buffer_load_dwordx4 a[168:171], v2, s[8:11], s35 offen offset:1024 nt
    s_waitcnt vmcnt(9)
    buffer_load_dwordx4 a[172:175], v2, s[8:11], s35 offen offset:2048 nt
    v_mov_b32 v96, 0
    v_mov_b32 v97, 0
    v_mov_b32 v98, 0
    v_mov_b32 v99, 0
    v_mov_b32 v100, 0
    v_mov_b32 v101, 0
    v_mov_b32 v102, 0
    v_mov_b32 v103, 0
    v_mov_b32 v104, 0
    v_mov_b32 v105, 0
    v_mov_b32 v106, 0
    v_mov_b32 v107, 0
    v_mov_b32 v108, 0
    v_mov_b32 v109, 0
    v_mov_b32 v110, 0
    v_mov_b32 v111, 0
    v_mov_b32 v112, 0
    v_mov_b32 v113, 0
    v_mov_b32 v114, 0
    v_mov_b32 v115, 0
    v_mov_b32 v116, 0
    v_mov_b32 v117, 0
    v_mov_b32 v118, 0
    v_mov_b32 v119, 0
    global_load_dword v147, v146, s[26:27] sc1
    s_nop 0
    v_mfma_f32_4x4x4_16b_bf16 v[20:23], v[16:17], a[64:65], v[20:23] cbsz:2 abid:0
    v_mfma_f32_4x4x4_16b_bf16 v[24:27], v[16:17], a[66:67], v[24:27] cbsz:2 abid:0
    v_mfma_f32_4x4x4_16b_bf16 v[28:31], v[16:17], a[72:73], v[28:31] cbsz:2 abid:1
    v_mfma_f32_4x4x4_16b_bf16 v[32:35], v[16:17], a[74:75], v[32:35] cbsz:2 abid:1
    v_mfma_f32_4x4x4_16b_bf16 v[20:23], v[16:17], a[76:77], v[20:23] cbsz:2 abid:2
    v_mfma_f32_4x4x4_16b_bf16 v[24:27], v[16:17], a[78:79], v[24:27] cbsz:2 abid:2
    v_mfma_f32_4x4x4_16b_bf16 v[28:31], v[16:17], a[100:101], v[28:31] cbsz:2 abid:3
    v_mfma_f32_4x4x4_16b_bf16 v[32:35], v[16:17], a[102:103], v[32:35] cbsz:2 abid:3
    v_perm_b32 v16, v69, v69, v6
    v_perm_b32 v17, v69, v69, v7
    buffer_load_dwordx4 a[192:195], v2, s[16:19], s39 offen offset:1280
    s_waitcnt vmcnt(11)
    buffer_load_dwordx4 a[196:199], v2, s[8:11], s35 offen offset:3072 nt
    s_add_u32 s35, s35, 16384
    s_waitcnt vmcnt(10)
    buffer_load_dwordx4 a[200:203], v2, s[8:11], s35 offen offset:0 nt
    buffer_load_dwordx4 a[204:207], v2, s[16:19], s39 offen offset:2560
    s_waitcnt vmcnt(11)
    buffer_load_dwordx4 a[224:227], v2, s[8:11], s35 offen offset:1024 nt
    s_waitcnt vmcnt(10)
    buffer_load_dwordx4 a[228:231], v2, s[8:11], s35 offen offset:2048 nt
    s_nop 0
    v_mfma_f32_4x4x4_16b_bf16 v[20:23], v[18:19], a[104:105], v[20:23] cbsz:2 abid:0
    v_mfma_f32_4x4x4_16b_bf16 v[24:27], v[18:19], a[106:107], v[24:27] cbsz:2 abid:0
    v_mfma_f32_4x4x4_16b_bf16 v[28:31], v[18:19], a[128:129], v[28:31] cbsz:2 abid:1
    v_mfma_f32_4x4x4_16b_bf16 v[32:35], v[18:19], a[130:131], v[32:35] cbsz:2 abid:1
    v_mfma_f32_4x4x4_16b_bf16 v[20:23], v[18:19], a[132:133], v[20:23] cbsz:2 abid:2
    v_mfma_f32_4x4x4_16b_bf16 v[24:27], v[18:19], a[134:135], v[24:27] cbsz:2 abid:2
    v_mfma_f32_4x4x4_16b_bf16 v[28:31], v[18:19], a[140:141], v[28:31] cbsz:2 abid:3
    v_mfma_f32_4x4x4_16b_bf16 v[32:35], v[18:19], a[142:143], v[32:35] cbsz:2 abid:3
    v_perm_b32 v18, v69, v69, v8
    v_perm_b32 v19, v69, v69, v9
    buffer_load_dwordx4 a[232:235], v2, s[16:19], s39 offen offset:3840
    s_waitcnt vmcnt(11)
    buffer_load_dwordx4 a[236:239], v2, s[8:11], s35 offen offset:3072 nt
    s_add_u32 s35, s35, 16384
    s_waitcnt vmcnt(10)
    buffer_load_dwordx4 v[176:179], v2, s[8:11], s35 offen offset:0 nt
    buffer_load_dwordx4 v[180:183], v4, s[16:19], s39 offen offset:1024
    s_waitcnt vmcnt(11)
    buffer_load_dwordx4 v[184:187], v2, s[8:11], s35 offen offset:1024 nt
    s_waitcnt vmcnt(9)
    buffer_load_dwordx4 v[188:191], v2, s[8:11], s35 offen offset:2048 nt
    s_nop 0
    v_mfma_f32_4x4x4_16b_bf16 v[20:23], v[16:17], a[160:161], v[20:23] cbsz:2 abid:0
    v_mfma_f32_4x4x4_16b_bf16 v[24:27], v[16:17], a[162:163], v[24:27] cbsz:2 abid:0
    v_mfma_f32_4x4x4_16b_bf16 v[28:31], v[16:17], a[168:169], v[28:31] cbsz:2 abid:1
    v_mfma_f32_4x4x4_16b_bf16 v[32:35], v[16:17], a[170:171], v[32:35] cbsz:2 abid:1
    v_mfma_f32_4x4x4_16b_bf16 v[20:23], v[16:17], a[172:173], v[20:23] cbsz:2 abid:2
    v_mfma_f32_4x4x4_16b_bf16 v[24:27], v[16:17], a[174:175], v[24:27] cbsz:2 abid:2
    v_mfma_f32_4x4x4_16b_bf16 v[28:31], v[16:17], a[196:197], v[28:31] cbsz:2 abid:3
    v_mfma_f32_4x4x4_16b_bf16 v[32:35], v[16:17], a[198:199], v[32:35] cbsz:2 abid:3
    v_perm_b32 v16, v70, v70, v6
    v_perm_b32 v17, v70, v70, v7
    s_add_u32 s39, s37, 25600
    buffer_load_dwordx4 v[208:211], v2, s[16:19], s39 offen offset:0
    s_waitcnt vmcnt(10)
    buffer_load_dwordx4 v[212:215], v2, s[8:11], s35 offen offset:3072 nt
    s_add_u32 s35, s35, 16384
    s_waitcnt vmcnt(9)
    buffer_load_dwordx4 v[216:219], v2, s[8:11], s35 offen offset:0 nt
    buffer_load_dwordx4 v[220:223], v2, s[16:19], s39 offen offset:1280
    s_waitcnt vmcnt(10)
    buffer_load_dwordx4 a[16:19], v2, s[8:11], s35 offen offset:1024 nt
    s_waitcnt vmcnt(9)
    buffer_load_dwordx4 a[24:27], v2, s[8:11], s35 offen offset:2048 nt
    s_nop 0
    v_mfma_f32_4x4x4_16b_bf16 v[20:23], v[18:19], a[200:201], v[20:23] cbsz:2 abid:0
    v_mfma_f32_4x4x4_16b_bf16 v[24:27], v[18:19], a[202:203], v[24:27] cbsz:2 abid:0
    v_mfma_f32_4x4x4_16b_bf16 v[28:31], v[18:19], a[224:225], v[28:31] cbsz:2 abid:1
    v_mfma_f32_4x4x4_16b_bf16 v[32:35], v[18:19], a[226:227], v[32:35] cbsz:2 abid:1
    v_mfma_f32_4x4x4_16b_bf16 v[20:23], v[18:19], a[228:229], v[20:23] cbsz:2 abid:2
    v_mfma_f32_4x4x4_16b_bf16 v[24:27], v[18:19], a[230:231], v[24:27] cbsz:2 abid:2
    v_mfma_f32_4x4x4_16b_bf16 v[28:31], v[18:19], a[236:237], v[28:31] cbsz:2 abid:3
    v_mfma_f32_4x4x4_16b_bf16 v[32:35], v[18:19], a[238:239], v[32:35] cbsz:2 abid:3
    v_perm_b32 v18, v70, v70, v8
    v_perm_b32 v19, v70, v70, v9
    buffer_load_dwordx4 a[28:31], v2, s[16:19], s39 offen offset:2560
    s_waitcnt vmcnt(10)
    buffer_load_dwordx4 a[52:55], v2, s[8:11], s35 offen offset:3072 nt
    s_add_u32 s35, s35, 16384
    s_waitcnt vmcnt(9)
    buffer_load_dwordx4 a[56:59], v2, s[8:11], s35 offen offset:0 nt
    buffer_load_dwordx4 a[80:83], v2, s[16:19], s39 offen offset:3840
    s_waitcnt vmcnt(10)
    buffer_load_dwordx4 a[84:87], v2, s[8:11], s35 offen offset:1024 nt
    s_waitcnt vmcnt(9)
    buffer_load_dwordx4 a[92:95], v2, s[8:11], s35 offen offset:2048 nt
    s_nop 0
    v_mfma_f32_4x4x4_16b_bf16 v[20:23], v[16:17], v[176:177], v[20:23] cbsz:2 abid:0
    v_mfma_f32_4x4x4_16b_bf16 v[24:27], v[16:17], v[178:179], v[24:27] cbsz:2 abid:0
    v_mfma_f32_4x4x4_16b_bf16 v[28:31], v[16:17], v[184:185], v[28:31] cbsz:2 abid:1
    v_mfma_f32_4x4x4_16b_bf16 v[32:35], v[16:17], v[186:187], v[32:35] cbsz:2 abid:1
    v_mfma_f32_4x4x4_16b_bf16 v[20:23], v[16:17], v[188:189], v[20:23] cbsz:2 abid:2
    v_mfma_f32_4x4x4_16b_bf16 v[24:27], v[16:17], v[190:191], v[24:27] cbsz:2 abid:2
    v_mfma_f32_4x4x4_16b_bf16 v[28:31], v[16:17], v[212:213], v[28:31] cbsz:2 abid:3
    v_mfma_f32_4x4x4_16b_bf16 v[32:35], v[16:17], v[214:215], v[32:35] cbsz:2 abid:3
    v_perm_b32 v16, v71, v71, v6
    v_perm_b32 v17, v71, v71, v7
    buffer_load_dwordx4 a[112:115], v4, s[16:19], s39 offen offset:1024
    s_waitcnt vmcnt(10)
    buffer_load_dwordx4 a[120:123], v2, s[8:11], s35 offen offset:3072 nt
    s_add_u32 s35, s35, 16384
    s_waitcnt vmcnt(9)
    buffer_load_dwordx4 a[124:127], v2, s[8:11], s35 offen offset:0 nt
    s_add_u32 s39, s37, 30720
    buffer_load_dwordx4 a[148:151], v2, s[16:19], s39 offen offset:0
    s_waitcnt vmcnt(10)
    buffer_load_dwordx4 a[152:155], v2, s[8:11], s35 offen offset:1024 nt
    s_waitcnt vmcnt(9)
    buffer_load_dwordx4 a[176:179], v2, s[8:11], s35 offen offset:2048 nt
    s_nop 0
    v_mfma_f32_4x4x4_16b_bf16 v[20:23], v[18:19], v[216:217], v[20:23] cbsz:2 abid:0
    v_mfma_f32_4x4x4_16b_bf16 v[24:27], v[18:19], v[218:219], v[24:27] cbsz:2 abid:0
    v_mfma_f32_4x4x4_16b_bf16 v[28:31], v[18:19], a[16:17], v[28:31] cbsz:2 abid:1
    v_mfma_f32_4x4x4_16b_bf16 v[32:35], v[18:19], a[18:19], v[32:35] cbsz:2 abid:1
    v_mfma_f32_4x4x4_16b_bf16 v[20:23], v[18:19], a[24:25], v[20:23] cbsz:2 abid:2
    v_mfma_f32_4x4x4_16b_bf16 v[24:27], v[18:19], a[26:27], v[24:27] cbsz:2 abid:2
    v_mfma_f32_4x4x4_16b_bf16 v[28:31], v[18:19], a[52:53], v[28:31] cbsz:2 abid:3
    v_mfma_f32_4x4x4_16b_bf16 v[32:35], v[18:19], a[54:55], v[32:35] cbsz:2 abid:3
    v_perm_b32 v18, v71, v71, v8
    v_perm_b32 v19, v71, v71, v9
    buffer_load_dwordx4 a[180:183], v2, s[16:19], s39 offen offset:1280
    s_waitcnt vmcnt(10)
    buffer_load_dwordx4 a[188:191], v2, s[8:11], s35 offen offset:3072 nt
    s_add_u32 s35, s35, 16384
    s_waitcnt vmcnt(9)
    buffer_load_dwordx4 a[208:211], v2, s[8:11], s35 offen offset:0 nt
    buffer_load_dwordx4 a[216:219], v2, s[16:19], s39 offen offset:2560
    s_waitcnt vmcnt(10)
    buffer_load_dwordx4 a[220:223], v2, s[8:11], s35 offen offset:1024 nt
    s_waitcnt vmcnt(9)
    buffer_load_dwordx4 a[244:247], v2, s[8:11], s35 offen offset:2048 nt
    s_nop 0
    v_mfma_f32_4x4x4_16b_bf16 v[20:23], v[16:17], a[56:57], v[20:23] cbsz:2 abid:0
    v_mfma_f32_4x4x4_16b_bf16 v[24:27], v[16:17], a[58:59], v[24:27] cbsz:2 abid:0
    v_mfma_f32_4x4x4_16b_bf16 v[28:31], v[16:17], a[84:85], v[28:31] cbsz:2 abid:1
    v_mfma_f32_4x4x4_16b_bf16 v[32:35], v[16:17], a[86:87], v[32:35] cbsz:2 abid:1
    v_mfma_f32_4x4x4_16b_bf16 v[20:23], v[16:17], a[92:93], v[20:23] cbsz:2 abid:2
    v_mfma_f32_4x4x4_16b_bf16 v[24:27], v[16:17], a[94:95], v[24:27] cbsz:2 abid:2
    v_mfma_f32_4x4x4_16b_bf16 v[28:31], v[16:17], a[120:121], v[28:31] cbsz:2 abid:3
    v_mfma_f32_4x4x4_16b_bf16 v[32:35], v[16:17], a[122:123], v[32:35] cbsz:2 abid:3
    v_perm_b32 v16, v72, v72, v6
    v_perm_b32 v17, v72, v72, v7
    buffer_load_dwordx4 a[248:251], v2, s[16:19], s39 offen offset:3840
    s_waitcnt vmcnt(10)
    buffer_load_dwordx4 v[192:195], v2, s[8:11], s35 offen offset:3072 nt
    s_add_u32 s35, s35, 16384
    s_waitcnt vmcnt(9)
    buffer_load_dwordx4 v[196:199], v2, s[8:11], s35 offen offset:0 nt
    buffer_load_dwordx4 v[204:207], v4, s[16:19], s39 offen offset:1024
    s_waitcnt vmcnt(10)
    buffer_load_dwordx4 v[224:227], v2, s[8:11], s35 offen offset:1024 nt
    s_waitcnt vmcnt(9)
    buffer_load_dwordx4 v[232:235], v2, s[8:11], s35 offen offset:2048 nt
    s_nop 0
    v_mfma_f32_4x4x4_16b_bf16 v[20:23], v[18:19], a[124:125], v[20:23] cbsz:2 abid:0
    v_mfma_f32_4x4x4_16b_bf16 v[24:27], v[18:19], a[126:127], v[24:27] cbsz:2 abid:0
    v_mfma_f32_4x4x4_16b_bf16 v[28:31], v[18:19], a[152:153], v[28:31] cbsz:2 abid:1
    v_mfma_f32_4x4x4_16b_bf16 v[32:35], v[18:19], a[154:155], v[32:35] cbsz:2 abid:1
    v_mfma_f32_4x4x4_16b_bf16 v[20:23], v[18:19], a[176:177], v[20:23] cbsz:2 abid:2
    v_mfma_f32_4x4x4_16b_bf16 v[24:27], v[18:19], a[178:179], v[24:27] cbsz:2 abid:2
    v_mfma_f32_4x4x4_16b_bf16 v[28:31], v[18:19], a[188:189], v[28:31] cbsz:2 abid:3
    v_mfma_f32_4x4x4_16b_bf16 v[32:35], v[18:19], a[190:191], v[32:35] cbsz:2 abid:3
    v_perm_b32 v18, v72, v72, v8
    v_perm_b32 v19, v72, v72, v9
    s_add_u32 s39, s37, 35840
    buffer_load_dwordx4 v[236:239], v2, s[16:19], s39 offen offset:0
    s_waitcnt vmcnt(10)
    buffer_load_dwordx4 a[4:7], v2, s[8:11], s35 offen offset:3072 nt
    s_add_u32 s35, s35, 16384
    s_waitcnt vmcnt(9)
    buffer_load_dwordx4 a[8:11], v2, s[8:11], s35 offen offset:0 nt
    buffer_load_dwordx4 a[32:35], v2, s[16:19], s39 offen offset:1280
    s_waitcnt vmcnt(10)
    buffer_load_dwordx4 a[36:39], v2, s[8:11], s35 offen offset:1024 nt
    s_waitcnt vmcnt(9)
    buffer_load_dwordx4 a[44:47], v2, s[8:11], s35 offen offset:2048 nt
    s_nop 0
    v_mfma_f32_4x4x4_16b_bf16 v[20:23], v[16:17], a[208:209], v[20:23] cbsz:2 abid:0
    v_mfma_f32_4x4x4_16b_bf16 v[24:27], v[16:17], a[210:211], v[24:27] cbsz:2 abid:0
    v_mfma_f32_4x4x4_16b_bf16 v[28:31], v[16:17], a[220:221], v[28:31] cbsz:2 abid:1
    v_mfma_f32_4x4x4_16b_bf16 v[32:35], v[16:17], a[222:223], v[32:35] cbsz:2 abid:1
    v_mfma_f32_4x4x4_16b_bf16 v[20:23], v[16:17], a[244:245], v[20:23] cbsz:2 abid:2
    v_mfma_f32_4x4x4_16b_bf16 v[24:27], v[16:17], a[246:247], v[24:27] cbsz:2 abid:2
    v_mfma_f32_4x4x4_16b_bf16 v[28:31], v[16:17], v[192:193], v[28:31] cbsz:2 abid:3
    v_mfma_f32_4x4x4_16b_bf16 v[32:35], v[16:17], v[194:195], v[32:35] cbsz:2 abid:3
    v_perm_b32 v16, v73, v73, v6
    v_perm_b32 v17, v73, v73, v7
    buffer_load_dwordx4 a[64:67], v2, s[16:19], s39 offen offset:2560
    s_waitcnt vmcnt(10)
    buffer_load_dwordx4 a[72:75], v2, s[8:11], s35 offen offset:3072 nt
    s_add_u32 s35, s35, 16384
    s_waitcnt vmcnt(9)
    buffer_load_dwordx4 a[76:79], v2, s[8:11], s35 offen offset:0 nt
    buffer_load_dwordx4 a[100:103], v2, s[16:19], s39 offen offset:3840
    s_waitcnt vmcnt(10)
    buffer_load_dwordx4 a[104:107], v2, s[8:11], s35 offen offset:1024 nt
    s_waitcnt vmcnt(9)
    buffer_load_dwordx4 a[128:131], v2, s[8:11], s35 offen offset:2048 nt
    s_nop 0
    v_mfma_f32_4x4x4_16b_bf16 v[20:23], v[18:19], v[196:197], v[20:23] cbsz:2 abid:0
    v_mfma_f32_4x4x4_16b_bf16 v[24:27], v[18:19], v[198:199], v[24:27] cbsz:2 abid:0
    v_mfma_f32_4x4x4_16b_bf16 v[28:31], v[18:19], v[224:225], v[28:31] cbsz:2 abid:1
    v_mfma_f32_4x4x4_16b_bf16 v[32:35], v[18:19], v[226:227], v[32:35] cbsz:2 abid:1
    v_mfma_f32_4x4x4_16b_bf16 v[20:23], v[18:19], v[232:233], v[20:23] cbsz:2 abid:2
    v_mfma_f32_4x4x4_16b_bf16 v[24:27], v[18:19], v[234:235], v[24:27] cbsz:2 abid:2
    v_mfma_f32_4x4x4_16b_bf16 v[28:31], v[18:19], a[4:5], v[28:31] cbsz:2 abid:3
    v_mfma_f32_4x4x4_16b_bf16 v[32:35], v[18:19], a[6:7], v[32:35] cbsz:2 abid:3
    v_perm_b32 v18, v73, v73, v8
    v_perm_b32 v19, v73, v73, v9
    buffer_load_dwordx4 a[132:135], v4, s[16:19], s39 offen offset:1024
    s_waitcnt vmcnt(10)
    buffer_load_dwordx4 a[140:143], v2, s[8:11], s35 offen offset:3072 nt
    s_add_u32 s35, s35, 16384
    s_waitcnt vmcnt(9)
    buffer_load_dwordx4 a[160:163], v2, s[8:11], s35 offen offset:0 nt
    s_waitcnt vmcnt(9)
    buffer_load_dwordx4 a[168:171], v2, s[8:11], s35 offen offset:1024 nt
    s_waitcnt vmcnt(8)
    buffer_load_dwordx4 a[172:175], v2, s[8:11], s35 offen offset:2048 nt
    s_nop 0
    v_mfma_f32_4x4x4_16b_bf16 v[20:23], v[16:17], a[8:9], v[20:23] cbsz:2 abid:0
    v_mfma_f32_4x4x4_16b_bf16 v[24:27], v[16:17], a[10:11], v[24:27] cbsz:2 abid:0
    v_mfma_f32_4x4x4_16b_bf16 v[28:31], v[16:17], a[36:37], v[28:31] cbsz:2 abid:1
    v_mfma_f32_4x4x4_16b_bf16 v[32:35], v[16:17], a[38:39], v[32:35] cbsz:2 abid:1
    v_mfma_f32_4x4x4_16b_bf16 v[20:23], v[16:17], a[44:45], v[20:23] cbsz:2 abid:2
    v_mfma_f32_4x4x4_16b_bf16 v[24:27], v[16:17], a[46:47], v[24:27] cbsz:2 abid:2
    v_mfma_f32_4x4x4_16b_bf16 v[28:31], v[16:17], a[72:73], v[28:31] cbsz:2 abid:3
    v_mfma_f32_4x4x4_16b_bf16 v[32:35], v[16:17], a[74:75], v[32:35] cbsz:2 abid:3
    v_perm_b32 v16, v74, v74, v6
    v_perm_b32 v17, v74, v74, v7
    s_waitcnt vmcnt(8)
    buffer_load_dwordx4 a[196:199], v2, s[8:11], s35 offen offset:3072 nt
    s_add_u32 s35, s35, 16384
    s_waitcnt vmcnt(7)
    buffer_load_dwordx4 a[200:203], v2, s[8:11], s35 offen offset:0 nt
    s_waitcnt vmcnt(7)
    buffer_load_dwordx4 a[224:227], v2, s[8:11], s35 offen offset:1024 nt
    s_waitcnt vmcnt(6)
    buffer_load_dwordx4 a[228:231], v2, s[8:11], s35 offen offset:2048 nt
    s_nop 0
    v_mfma_f32_4x4x4_16b_bf16 v[20:23], v[18:19], a[76:77], v[20:23] cbsz:2 abid:0
    v_mfma_f32_4x4x4_16b_bf16 v[24:27], v[18:19], a[78:79], v[24:27] cbsz:2 abid:0
    v_mfma_f32_4x4x4_16b_bf16 v[28:31], v[18:19], a[104:105], v[28:31] cbsz:2 abid:1
    v_mfma_f32_4x4x4_16b_bf16 v[32:35], v[18:19], a[106:107], v[32:35] cbsz:2 abid:1
    v_mfma_f32_4x4x4_16b_bf16 v[20:23], v[18:19], a[128:129], v[20:23] cbsz:2 abid:2
    v_mfma_f32_4x4x4_16b_bf16 v[24:27], v[18:19], a[130:131], v[24:27] cbsz:2 abid:2
    v_mfma_f32_4x4x4_16b_bf16 v[28:31], v[18:19], a[140:141], v[28:31] cbsz:2 abid:3
    v_mfma_f32_4x4x4_16b_bf16 v[32:35], v[18:19], a[142:143], v[32:35] cbsz:2 abid:3
    v_perm_b32 v18, v74, v74, v8
    v_perm_b32 v19, v74, v74, v9
    s_waitcnt vmcnt(6)
    buffer_load_dwordx4 a[236:239], v2, s[8:11], s35 offen offset:3072 nt
    s_add_u32 s35, s35, 16384
    s_waitcnt vmcnt(6)
    buffer_load_dwordx4 v[176:179], v2, s[8:11], s35 offen offset:0 nt
    s_waitcnt vmcnt(6)
    buffer_load_dwordx4 v[184:187], v2, s[8:11], s35 offen offset:1024 nt
    s_waitcnt vmcnt(6)
    buffer_load_dwordx4 v[188:191], v2, s[8:11], s35 offen offset:2048 nt
    s_nop 0
    v_mfma_f32_4x4x4_16b_bf16 v[20:23], v[16:17], a[160:161], v[20:23] cbsz:2 abid:0
    v_mfma_f32_4x4x4_16b_bf16 v[24:27], v[16:17], a[162:163], v[24:27] cbsz:2 abid:0
    v_mfma_f32_4x4x4_16b_bf16 v[28:31], v[16:17], a[168:169], v[28:31] cbsz:2 abid:1
    v_mfma_f32_4x4x4_16b_bf16 v[32:35], v[16:17], a[170:171], v[32:35] cbsz:2 abid:1
    v_mfma_f32_4x4x4_16b_bf16 v[20:23], v[16:17], a[172:173], v[20:23] cbsz:2 abid:2
    v_mfma_f32_4x4x4_16b_bf16 v[24:27], v[16:17], a[174:175], v[24:27] cbsz:2 abid:2
    v_mfma_f32_4x4x4_16b_bf16 v[28:31], v[16:17], a[196:197], v[28:31] cbsz:2 abid:3
    v_mfma_f32_4x4x4_16b_bf16 v[32:35], v[16:17], a[198:199], v[32:35] cbsz:2 abid:3
    v_perm_b32 v16, v75, v75, v6
    v_perm_b32 v17, v75, v75, v7
    s_waitcnt vmcnt(6)
    buffer_load_dwordx4 v[212:215], v2, s[8:11], s35 offen offset:3072 nt
    s_add_u32 s35, s35, 16384
    s_waitcnt vmcnt(6)
    buffer_load_dwordx4 v[216:219], v2, s[8:11], s35 offen offset:0 nt
    s_waitcnt vmcnt(6)
    buffer_load_dwordx4 a[16:19], v2, s[8:11], s35 offen offset:1024 nt
    s_waitcnt vmcnt(6)
    buffer_load_dwordx4 a[24:27], v2, s[8:11], s35 offen offset:2048 nt
    s_nop 0
    v_mfma_f32_4x4x4_16b_bf16 v[20:23], v[18:19], a[200:201], v[20:23] cbsz:2 abid:0
    v_mfma_f32_4x4x4_16b_bf16 v[24:27], v[18:19], a[202:203], v[24:27] cbsz:2 abid:0
    v_mfma_f32_4x4x4_16b_bf16 v[28:31], v[18:19], a[224:225], v[28:31] cbsz:2 abid:1
    v_mfma_f32_4x4x4_16b_bf16 v[32:35], v[18:19], a[226:227], v[32:35] cbsz:2 abid:1
    v_mfma_f32_4x4x4_16b_bf16 v[20:23], v[18:19], a[228:229], v[20:23] cbsz:2 abid:2
    v_mfma_f32_4x4x4_16b_bf16 v[24:27], v[18:19], a[230:231], v[24:27] cbsz:2 abid:2
    v_mfma_f32_4x4x4_16b_bf16 v[28:31], v[18:19], a[236:237], v[28:31] cbsz:2 abid:3
    v_mfma_f32_4x4x4_16b_bf16 v[32:35], v[18:19], a[238:239], v[32:35] cbsz:2 abid:3
    v_perm_b32 v18, v75, v75, v8
    v_perm_b32 v19, v75, v75, v9
    s_waitcnt vmcnt(6)
    buffer_load_dwordx4 a[52:55], v2, s[8:11], s35 offen offset:3072 nt
    s_waitcnt vmcnt(4)
    s_nop 0
    v_mfma_f32_4x4x4_16b_bf16 v[20:23], v[16:17], v[176:177], v[20:23] cbsz:2 abid:0
    v_mfma_f32_4x4x4_16b_bf16 v[24:27], v[16:17], v[178:179], v[24:27] cbsz:2 abid:0
    v_mfma_f32_4x4x4_16b_bf16 v[28:31], v[16:17], v[184:185], v[28:31] cbsz:2 abid:1
    v_mfma_f32_4x4x4_16b_bf16 v[32:35], v[16:17], v[186:187], v[32:35] cbsz:2 abid:1
    v_mfma_f32_4x4x4_16b_bf16 v[20:23], v[16:17], v[188:189], v[20:23] cbsz:2 abid:2
    v_mfma_f32_4x4x4_16b_bf16 v[24:27], v[16:17], v[190:191], v[24:27] cbsz:2 abid:2
    v_mfma_f32_4x4x4_16b_bf16 v[28:31], v[16:17], v[212:213], v[28:31] cbsz:2 abid:3
    v_mfma_f32_4x4x4_16b_bf16 v[32:35], v[16:17], v[214:215], v[32:35] cbsz:2 abid:3
    s_waitcnt vmcnt(0)
    s_nop 0
    v_mfma_f32_4x4x4_16b_bf16 v[20:23], v[18:19], v[216:217], v[20:23] cbsz:2 abid:0
    v_mfma_f32_4x4x4_16b_bf16 v[24:27], v[18:19], v[218:219], v[24:27] cbsz:2 abid:0
    v_mfma_f32_4x4x4_16b_bf16 v[28:31], v[18:19], a[16:17], v[28:31] cbsz:2 abid:1
    v_mfma_f32_4x4x4_16b_bf16 v[32:35], v[18:19], a[18:19], v[32:35] cbsz:2 abid:1
    v_mfma_f32_4x4x4_16b_bf16 v[20:23], v[18:19], a[24:25], v[20:23] cbsz:2 abid:2
    v_mfma_f32_4x4x4_16b_bf16 v[24:27], v[18:19], a[26:27], v[24:27] cbsz:2 abid:2
    v_mfma_f32_4x4x4_16b_bf16 v[28:31], v[18:19], a[52:53], v[28:31] cbsz:2 abid:3
    v_mfma_f32_4x4x4_16b_bf16 v[32:35], v[18:19], a[54:55], v[32:35] cbsz:2 abid:3
    s_nop 3
    v_add_f32 v36, v20, v28
    v_add_f32 v40, v24, v32
    v_add_f32 v37, v21, v29
    v_add_f32 v41, v25, v33
    v_add_f32 v38, v22, v30
    v_add_f32 v42, v26, v34
    v_add_f32 v39, v23, v31
    v_add_f32 v43, v27, v35
    s_nop 1
    v_permlane32_swap_b32 v36, v40
    v_permlane32_swap_b32 v37, v41
    v_permlane32_swap_b32 v38, v42
    v_permlane32_swap_b32 v39, v43
    v_add_f32 v36, v36, v40
    v_add_f32 v37, v37, v41
    v_add_f32 v38, v38, v42
    v_add_f32 v39, v39, v43
    s_nop 0
    v_permlane16_swap_b32 v36, v38
    v_permlane16_swap_b32 v37, v39
    v_add_f32 v36, v36, v38
    v_add_f32 v37, v37, v39
    ds_write_b64 v136, v[36:37] offset:2304
    s_mov_b32 s74, 0
L_clrwait:
    v_cmp_eq_u32 vcc, 0, v147
    s_cbranch_vccz L_clrok
    global_load_dword v147, v146, s[26:27] sc1
    s_waitcnt vmcnt(0)
    s_add_u32 s74, s74, 1
    s_cmp_lt_u32 s74, 0x40000
    s_cbranch_scc1 L_clrwait
L_clrok:
    s_waitcnt lgkmcnt(0)
    s_barrier
    ds_read_b32 v76, v139 offset:2304
    ds_read_b32 v77, v139 offset:2816
    ds_read_b32 v78, v139 offset:3328
    ds_read_b32 v79, v139 offset:3840
    ds_read_b32 v80, v139 offset:2368
    ds_read_b32 v81, v139 offset:2880
    ds_read_b32 v82, v139 offset:3392
    ds_read_b32 v83, v139 offset:3904
    s_waitcnt lgkmcnt(0)
    v_add_f32 v76, v76, v77
    v_add_f32 v78, v78, v79
    v_add_f32 v80, v80, v81
    v_add_f32 v82, v82, v83
    v_add_f32 v76, v76, v78
    v_add_f32 v80, v80, v82
    v_cvt_pk_bf16_f32 v76, v76, v80
    v_perm_b32 v16, v76, v76, v6
    v_perm_b32 v17, v76, v76, v7
    v_perm_b32 v18, v76, v76, v8
    v_perm_b32 v19, v76, v76, v9
    s_nop 1
    v_mfma_f32_4x4x4_16b_bf16 v[96:99], v[16:17], a[20:21], v[96:99] cbsz:4 abid:0
    v_mfma_f32_4x4x4_16b_bf16 v[100:103], v[16:17], a[22:23], v[100:103] cbsz:4 abid:0
    v_mfma_f32_4x4x4_16b_bf16 v[104:107], v[16:17], a[48:49], v[104:107] cbsz:4 abid:4
    v_mfma_f32_4x4x4_16b_bf16 v[108:111], v[16:17], a[50:51], v[108:111] cbsz:4 abid:4
    v_mfma_f32_4x4x4_16b_bf16 v[96:99], v[16:17], a[60:61], v[96:99] cbsz:4 abid:8
    v_mfma_f32_4x4x4_16b_bf16 v[100:103], v[16:17], a[62:63], v[100:103] cbsz:4 abid:8
    v_mfma_f32_4x4x4_16b_bf16 v[104:107], v[16:17], a[88:89], v[104:107] cbsz:4 abid:12
    v_mfma_f32_4x4x4_16b_bf16 v[108:111], v[16:17], a[90:91], v[108:111] cbsz:4 abid:12
    v_mfma_f32_4x4x4_16b_bf16 v[112:115], v[16:17], a[116:117], v[112:115] cbsz:2 abid:0
    v_mfma_f32_4x4x4_16b_bf16 v[116:119], v[16:17], a[118:119], v[116:119] cbsz:2 abid:0
    v_mfma_f32_4x4x4_16b_bf16 v[96:99], v[16:17], a[144:145], v[96:99] cbsz:4 abid:1
    v_mfma_f32_4x4x4_16b_bf16 v[100:103], v[16:17], a[146:147], v[100:103] cbsz:4 abid:1
    v_mfma_f32_4x4x4_16b_bf16 v[104:107], v[16:17], a[156:157], v[104:107] cbsz:4 abid:5
    v_mfma_f32_4x4x4_16b_bf16 v[108:111], v[16:17], a[158:159], v[108:111] cbsz:4 abid:5
    v_mfma_f32_4x4x4_16b_bf16 v[96:99], v[16:17], a[184:185], v[96:99] cbsz:4 abid:9
    v_mfma_f32_4x4x4_16b_bf16 v[100:103], v[16:17], a[186:187], v[100:103] cbsz:4 abid:9
    v_mfma_f32_4x4x4_16b_bf16 v[104:107], v[16:17], a[212:213], v[104:107] cbsz:4 abid:13
    v_mfma_f32_4x4x4_16b_bf16 v[108:111], v[16:17], a[214:215], v[108:111] cbsz:4 abid:13
    v_mfma_f32_4x4x4_16b_bf16 v[112:115], v[16:17], a[240:241], v[112:115] cbsz:2 abid:1
    v_mfma_f32_4x4x4_16b_bf16 v[116:119], v[16:17], a[242:243], v[116:119] cbsz:2 abid:1
    v_mfma_f32_4x4x4_16b_bf16 v[96:99], v[16:17], a[252:253], v[96:99] cbsz:4 abid:2
    v_mfma_f32_4x4x4_16b_bf16 v[100:103], v[16:17], a[254:255], v[100:103] cbsz:4 abid:2
    v_mfma_f32_4x4x4_16b_bf16 v[104:107], v[16:17], v[200:201], v[104:107] cbsz:4 abid:6
    v_mfma_f32_4x4x4_16b_bf16 v[108:111], v[16:17], v[202:203], v[108:111] cbsz:4 abid:6
    v_mfma_f32_4x4x4_16b_bf16 v[96:99], v[16:17], v[228:229], v[96:99] cbsz:4 abid:10
    v_mfma_f32_4x4x4_16b_bf16 v[100:103], v[16:17], v[230:231], v[100:103] cbsz:4 abid:10
    v_mfma_f32_4x4x4_16b_bf16 v[104:107], v[16:17], a[0:1], v[104:107] cbsz:4 abid:14
    v_mfma_f32_4x4x4_16b_bf16 v[108:111], v[16:17], a[2:3], v[108:111] cbsz:4 abid:14
    v_mfma_f32_4x4x4_16b_bf16 v[112:115], v[16:17], a[12:13], v[112:115] cbsz:2 abid:2
    v_mfma_f32_4x4x4_16b_bf16 v[116:119], v[16:17], a[14:15], v[116:119] cbsz:2 abid:2
    v_mfma_f32_4x4x4_16b_bf16 v[96:99], v[16:17], a[40:41], v[96:99] cbsz:4 abid:3
    v_mfma_f32_4x4x4_16b_bf16 v[100:103], v[16:17], a[42:43], v[100:103] cbsz:4 abid:3
    v_mfma_f32_4x4x4_16b_bf16 v[104:107], v[16:17], a[68:69], v[104:107] cbsz:4 abid:7
    v_mfma_f32_4x4x4_16b_bf16 v[108:111], v[16:17], a[70:71], v[108:111] cbsz:4 abid:7
    v_mfma_f32_4x4x4_16b_bf16 v[96:99], v[16:17], a[96:97], v[96:99] cbsz:4 abid:11
    v_mfma_f32_4x4x4_16b_bf16 v[100:103], v[16:17], a[98:99], v[100:103] cbsz:4 abid:11
    v_mfma_f32_4x4x4_16b_bf16 v[104:107], v[16:17], a[108:109], v[104:107] cbsz:4 abid:15
    v_mfma_f32_4x4x4_16b_bf16 v[108:111], v[16:17], a[110:111], v[108:111] cbsz:4 abid:15
    v_mfma_f32_4x4x4_16b_bf16 v[112:115], v[16:17], a[136:137], v[112:115] cbsz:2 abid:3
    v_mfma_f32_4x4x4_16b_bf16 v[116:119], v[16:17], a[138:139], v[116:119] cbsz:2 abid:3
    v_mfma_f32_4x4x4_16b_bf16 v[96:99], v[18:19], a[164:165], v[96:99] cbsz:4 abid:0
    v_mfma_f32_4x4x4_16b_bf16 v[100:103], v[18:19], a[166:167], v[100:103] cbsz:4 abid:0
    v_mfma_f32_4x4x4_16b_bf16 v[104:107], v[18:19], a[192:193], v[104:107] cbsz:4 abid:4
    v_mfma_f32_4x4x4_16b_bf16 v[108:111], v[18:19], a[194:195], v[108:111] cbsz:4 abid:4
    v_mfma_f32_4x4x4_16b_bf16 v[96:99], v[18:19], a[204:205], v[96:99] cbsz:4 abid:8
    v_mfma_f32_4x4x4_16b_bf16 v[100:103], v[18:19], a[206:207], v[100:103] cbsz:4 abid:8
    v_mfma_f32_4x4x4_16b_bf16 v[104:107], v[18:19], a[232:233], v[104:107] cbsz:4 abid:12
    v_mfma_f32_4x4x4_16b_bf16 v[108:111], v[18:19], a[234:235], v[108:111] cbsz:4 abid:12
    v_mfma_f32_4x4x4_16b_bf16 v[112:115], v[18:19], v[180:181], v[112:115] cbsz:2 abid:0
    v_mfma_f32_4x4x4_16b_bf16 v[116:119], v[18:19], v[182:183], v[116:119] cbsz:2 abid:0
    v_mfma_f32_4x4x4_16b_bf16 v[96:99], v[18:19], v[208:209], v[96:99] cbsz:4 abid:1
    v_mfma_f32_4x4x4_16b_bf16 v[100:103], v[18:19], v[210:211], v[100:103] cbsz:4 abid:1
    v_mfma_f32_4x4x4_16b_bf16 v[104:107], v[18:19], v[220:221], v[104:107] cbsz:4 abid:5
    v_mfma_f32_4x4x4_16b_bf16 v[108:111], v[18:19], v[222:223], v[108:111] cbsz:4 abid:5
    v_mfma_f32_4x4x4_16b_bf16 v[96:99], v[18:19], a[28:29], v[96:99] cbsz:4 abid:9
    v_mfma_f32_4x4x4_16b_bf16 v[100:103], v[18:19], a[30:31], v[100:103] cbsz:4 abid:9
    v_mfma_f32_4x4x4_16b_bf16 v[104:107], v[18:19], a[80:81], v[104:107] cbsz:4 abid:13
    v_mfma_f32_4x4x4_16b_bf16 v[108:111], v[18:19], a[82:83], v[108:111] cbsz:4 abid:13
    v_mfma_f32_4x4x4_16b_bf16 v[112:115], v[18:19], a[112:113], v[112:115] cbsz:2 abid:1
    v_mfma_f32_4x4x4_16b_bf16 v[116:119], v[18:19], a[114:115], v[116:119] cbsz:2 abid:1
    v_mfma_f32_4x4x4_16b_bf16 v[96:99], v[18:19], a[148:149], v[96:99] cbsz:4 abid:2
    v_mfma_f32_4x4x4_16b_bf16 v[100:103], v[18:19], a[150:151], v[100:103] cbsz:4 abid:2
    v_mfma_f32_4x4x4_16b_bf16 v[104:107], v[18:19], a[180:181], v[104:107] cbsz:4 abid:6
    v_mfma_f32_4x4x4_16b_bf16 v[108:111], v[18:19], a[182:183], v[108:111] cbsz:4 abid:6
    v_mfma_f32_4x4x4_16b_bf16 v[96:99], v[18:19], a[216:217], v[96:99] cbsz:4 abid:10
    v_mfma_f32_4x4x4_16b_bf16 v[100:103], v[18:19], a[218:219], v[100:103] cbsz:4 abid:10
    v_mfma_f32_4x4x4_16b_bf16 v[104:107], v[18:19], a[248:249], v[104:107] cbsz:4 abid:14
    v_mfma_f32_4x4x4_16b_bf16 v[108:111], v[18:19], a[250:251], v[108:111] cbsz:4 abid:14
    v_mfma_f32_4x4x4_16b_bf16 v[112:115], v[18:19], v[204:205], v[112:115] cbsz:2 abid:2
    v_mfma_f32_4x4x4_16b_bf16 v[116:119], v[18:19], v[206:207], v[116:119] cbsz:2 abid:2
    v_mfma_f32_4x4x4_16b_bf16 v[96:99], v[18:19], v[236:237], v[96:99] cbsz:4 abid:3
    v_mfma_f32_4x4x4_16b_bf16 v[100:103], v[18:19], v[238:239], v[100:103] cbsz:4 abid:3
    v_mfma_f32_4x4x4_16b_bf16 v[104:107], v[18:19], a[32:33], v[104:107] cbsz:4 abid:7
    v_mfma_f32_4x4x4_16b_bf16 v[108:111], v[18:19], a[34:35], v[108:111] cbsz:4 abid:7
    v_mfma_f32_4x4x4_16b_bf16 v[96:99], v[18:19], a[64:65], v[96:99] cbsz:4 abid:11
    v_mfma_f32_4x4x4_16b_bf16 v[100:103], v[18:19], a[66:67], v[100:103] cbsz:4 abid:11
    v_mfma_f32_4x4x4_16b_bf16 v[104:107], v[18:19], a[100:101], v[104:107] cbsz:4 abid:15
    v_mfma_f32_4x4x4_16b_bf16 v[108:111], v[18:19], a[102:103], v[108:111] cbsz:4 abid:15
    v_mfma_f32_4x4x4_16b_bf16 v[112:115], v[18:19], a[132:133], v[112:115] cbsz:2 abid:3
    v_mfma_f32_4x4x4_16b_bf16 v[116:119], v[18:19], a[134:135], v[116:119] cbsz:2 abid:3
    s_nop 2
    v_add_f32 v96, v96, v104
    v_add_f32 v97, v97, v105
    v_add_f32 v98, v98, v106
    v_add_f32 v99, v99, v107
    v_add_f32 v100, v100, v108
    v_add_f32 v101, v101, v109
    v_add_f32 v102, v102, v110
    v_add_f32 v103, v103, v111
    ds_write_b128 v142, v[96:99] offset:4608
    ds_write_b128 v142, v[100:103] offset:5632
    s_nop 1
    v_permlane32_swap_b32 v112, v116
    v_permlane32_swap_b32 v113, v117
    v_permlane32_swap_b32 v114, v118
    v_permlane32_swap_b32 v115, v119
    v_add_f32 v112, v112, v116
    v_add_f32 v113, v113, v117
    v_add_f32 v114, v114, v118
    v_add_f32 v115, v115, v119
    s_nop 0
    v_permlane16_swap_b32 v112, v114
    v_permlane16_swap_b32 v113, v115
    v_add_f32 v112, v112, v114
    v_add_f32 v113, v113, v115
    ds_write_b64 v143, v[112:113] offset:6656
    s_waitcnt lgkmcnt(0)
    s_barrier
    v_cmp_gt_u32 vcc, 160, v140
    s_and_saveexec_b64 s[72:73], vcc
    s_cbranch_execz L_skip1
    ds_read_b128 v[60:63], v144 offset:4608
    ds_read_b128 v[64:67], v144 offset:7168
    ds_read_b128 v[68:71], v144 offset:9728
    ds_read_b128 v[72:75], v144 offset:12288
    v_mov_b32 v76, -2
    s_waitcnt lgkmcnt(0)
    v_add_f32 v60, v60, v64
    v_add_f32 v68, v68, v72
    v_add_f32 v61, v61, v65
    v_add_f32 v69, v69, v73
    v_add_f32 v62, v62, v66
    v_add_f32 v70, v70, v74
    v_add_f32 v63, v63, v67
    v_add_f32 v71, v71, v75
    v_add_f32 v60, v60, v68
    v_add_f32 v61, v61, v69
    v_add_f32 v62, v62, v70
    v_add_f32 v63, v63, v71
    v_min_u32 v60, v60, v76
    v_min_u32 v61, v61, v76
    v_min_u32 v62, v62, v76
    v_min_u32 v63, v63, v76
    buffer_store_dwordx4 v[60:63], v141, s[52:55], s50 offen sc1
L_skip1:
    s_mov_b64 exec, s[72:73]
    s_cmp_ge_u32 s33, 5
    s_cbranch_scc1 L_fin
    s_mov_b32 s74, 0
    s_mov_b64 s[56:57], -1
    s_mov_b64 s[58:59], -1
    s_mov_b64 s[60:61], -1
    s_mov_b64 s[62:63], -1
L_poll:
    s_mov_b64 exec, s[56:57]
    s_cbranch_execz L_pskip0
    buffer_load_dwordx4 v[96:99], v145, s[52:55], s75 offen sc1
L_pskip0:
    s_mov_b64 exec, s[58:59]
    s_cbranch_execz L_pskip1
    buffer_load_dwordx4 v[100:103], v145, s[52:55], s76 offen sc1
L_pskip1:
    s_mov_b64 exec, s[60:61]
    s_cbranch_execz L_pskip2
    buffer_load_dwordx4 v[104:107], v145, s[52:55], s77 offen sc1
L_pskip2:
    s_mov_b64 exec, s[62:63]
    s_cbranch_execz L_pskip3
    buffer_load_dwordx4 v[108:111], v145, s[52:55], s78 offen sc1
L_pskip3:
    s_mov_b64 exec, -1
    s_waitcnt vmcnt(0)
    v_max3_u32 v112, v96, v97, v98
    v_max3_u32 v113, v100, v101, v102
    v_max3_u32 v114, v104, v105, v106
    v_max3_u32 v115, v108, v109, v110
    v_max_u32 v112, v112, v99
    v_max_u32 v113, v113, v103
    v_max_u32 v114, v114, v107
    v_max_u32 v115, v115, v111
    v_cmp_eq_u32 s[56:57], -1, v112
    v_cmp_eq_u32 s[58:59], -1, v113
    v_cmp_eq_u32 s[60:61], -1, v114
    v_cmp_eq_u32 s[62:63], -1, v115
    v_add_f32 v116, v96, v100
    v_add_f32 v117, v97, v101
    v_add_f32 v118, v98, v102
    v_add_f32 v119, v99, v103
    s_or_b64 s[64:65], s[56:57], s[58:59]
    s_or_b64 s[66:67], s[60:61], s[62:63]
    s_add_u32 s74, s74, 1
    s_cmp_lt_u32 s74, 0x40000
    s_cbranch_scc0 L_polldone
    s_or_b64 s[64:65], s[64:65], s[66:67]
    s_cbranch_scc0 L_polldone
    s_branch L_poll
L_polldone:
    v_add_f32 v104, v104, v108
    v_add_f32 v105, v105, v109
    v_add_f32 v106, v106, v110
    v_add_f32 v107, v107, v111
    v_add_f32 v116, v116, v104
    v_add_f32 v117, v117, v105
    v_add_f32 v118, v118, v106
    v_add_f32 v119, v119, v107
    s_nop 0
    v_add_f32_dpp v116, v116, v116 row_ror:8 row_mask:0xf bank_mask:0xf
    v_add_f32_dpp v117, v117, v117 row_ror:8 row_mask:0xf bank_mask:0xf
    v_add_f32_dpp v118, v118, v118 row_ror:8 row_mask:0xf bank_mask:0xf
    v_add_f32_dpp v119, v119, v119 row_ror:8 row_mask:0xf bank_mask:0xf
    s_nop 0
    v_permlane16_swap_b32 v116, v117
    v_permlane16_swap_b32 v118, v119
    v_add_f32 v116, v116, v117
    v_add_f32 v118, v118, v119
    s_nop 1
    v_permlane32_swap_b32 v116, v118
    v_add_f32 v116, v116, v118
    v_and_b32 v117, 8, v0
    v_cmp_eq_u32 vcc, 0, v117
    v_cvt_pk_bf16_f32 v116, v116, v116
    s_and_b64 exec, exec, vcc
    buffer_store_short v116, v148, s[68:71], 0 offen
L_fin:
L_end:
    s_endpgm
.section .rodata,"a"
.p2align 6
.amdhsa_kernel concat_heads__sliding_block_cached__sliding_block_cached__decode_kernel
  .amdhsa_next_free_vgpr 512
  .amdhsa_next_free_sgpr 102
  .amdhsa_accum_offset 256
  .amdhsa_group_segment_fixed_size 0
  .amdhsa_kernarg_size 104
  .amdhsa_user_sgpr_count 2
  .amdhsa_user_sgpr_kernarg_segment_ptr 1
  .amdhsa_system_sgpr_workgroup_id_x 1
.end_amdhsa_kernel
```
